```python
import torch

def _softmax(x, axis=-1):
    return torch.softmax(x, dim=axis)
def _gelu(x):
    return torch.nn.functional.gelu(x, approximate="tanh")
def _silu(x):
    return torch.nn.functional.silu(x)
def _sigmoid(x):
    return torch.sigmoid(x)
def _layernorm(x, axis=-1, eps=1e-5):
    m = x.mean(dim=axis, keepdim=True)
    v = x.var(dim=axis, keepdim=True, unbiased=False)
    return (x - m) / torch.sqrt(v + eps)
def _scatter_add(tgt, idx, src, axis=0):
    return tgt.clone().index_add_(axis, idx, src)
def _segment_sum(src, seg, n):
    out = torch.zeros((n,) + src.shape[1:], dtype=src.dtype)
    return out.index_add_(0, seg, src)
def _pad(x, pw):
    flat = tuple(v for pair in reversed(pw) for v in pair)
    return torch.nn.functional.pad(x, flat)

kernel_name = 'parallel_sum__sliding_local_dilated__glu_gated_swiglu__prompt'

def setup_inputs():

    _w = (lambda a: (lambda t: t.to(torch.bfloat16) if t.is_floating_point() else t)(torch.as_tensor(a)))
    def _A_setup():
        B, S, D = 1, 2048, 640
        return {
            "x": _w((lambda *s: torch.randn(*s, dtype=torch.bfloat16) * 0.05)(B, S, D)),
            "wqkv": _w((lambda *s: torch.randn(*s, dtype=torch.bfloat16) * 0.05)(D, 3 * D)),
            "wo": _w((lambda *s: torch.randn(*s, dtype=torch.bfloat16) * 0.05)(D, D)),
        }
    _A_in = _A_setup()

    def _B_setup():
        B, S, D, F = 1, 2048, 640, 1728
        return {
            "x": _w((lambda *s: torch.randn(*s, dtype=torch.bfloat16) * 0.05)(B, S, D)),
            "w1": _w((lambda *s: torch.randn(*s, dtype=torch.bfloat16) * 0.8)(D, F) * (2.0 / D) ** 0.5),
            "w3": _w((lambda *s: torch.randn(*s, dtype=torch.bfloat16) * 0.8)(D, F) * (2.0 / D) ** 0.5),
            "w2": _w((lambda *s: torch.randn(*s, dtype=torch.bfloat16) * 0.8)(F, D) * (2.0 / F) ** 0.5),
        }
    _B_in = _B_setup()

    return {
        "A_x": _A_in["x"],
        "A_wqkv": _A_in["wqkv"],
        "A_wo": _A_in["wo"],
        "B_x": _B_in["x"],
        "B_w1": _B_in["w1"],
        "B_w3": _B_in["w3"],
        "B_w2": _B_in["w2"],
    }

def reference(A_x, A_wqkv, A_wo, B_x, B_w1, B_w3, B_w2):
    def _A_ref(x, wqkv, wo):
        B, S, D = x.shape
        H = 32; Dh = D // H
        W, dil = 8, 2
        qkv = (lambda x, *d: x.permute(*d))((x @ wqkv).reshape(B, S, 3, H, Dh), 2, 0, 3, 1, 4)
        q, k, v = qkv[0], qkv[1], qkv[2]
        scale = Dh ** -0.5
        pos = torch.arange(S)
        off = torch.arange(W) * dil
        idx = pos[:, None] - off[None, :]
        mask = idx >= 0
        idx_c = torch.where(mask, idx, 0).reshape(-1)
        kg = k[:, :, idx_c, :].reshape(B, H, S, W, Dh)
        vg = v[:, :, idx_c, :].reshape(B, H, S, W, Dh)
        logits = torch.einsum("bhsd,bhswd->bhsw", q, kg) * scale
        logits = torch.where(mask[None, None, :, :], logits, -1e9)
        attn = _softmax(logits, axis=-1)
        o = torch.einsum("bhsw,bhswd->bhsd", attn, vg)
        return (lambda x, *d: x.permute(*d))(o, 0, 2, 1, 3).reshape(B, S, D) @ wo

    def _B_ref(x, w1, w3, w2):
        gate = torch.einsum("bsd,df->bsf", x, w1)
        up = torch.einsum("bsd,df->bsf", x, w3)
        h = _silu(gate) * up
        out = torch.einsum("bsf,fd->bsd", h, w2)
        return out

    x = A_x
    xn = _layernorm(x, axis=-1)
    return x + _A_ref(xn, A_wqkv, A_wo) + _B_ref(xn, B_w1, B_w3, B_w2)
```

```asm
; @launch grid=(256,1,1) block=(512,1,1) lds=163840
.amdgcn_target "amdgcn-amd-amdhsa--gfx950"
.text
.globl parallel_sum__sliding_local_dilated__glu_gated_swiglu__prompt_kernel
.p2align 8
.type parallel_sum__sliding_local_dilated__glu_gated_swiglu__prompt_kernel,@function
parallel_sum__sliding_local_dilated__glu_gated_swiglu__prompt_kernel:
    s_cmp_ge_u32 s2, 256
    s_cbranch_scc1 K_END
    s_load_dwordx16 s[4:19], s[0:1], 0
    s_load_dwordx4 s[20:23], s[0:1], 64
    v_and_b32 v255, 63, v0
    v_lshrrev_b32 v1, 6, v0
    v_lshlrev_b32 v254, 4, v255
    v_readfirstlane_b32 s40, v1
    s_and_b32 s68, s2, 7
    s_lshr_b32 s69, s2, 3
    s_cmp_lg_u32 s40, 7
    s_cbranch_scc1 NOCPF
    s_getpc_b64 s[70:71]
CPF_BASE:
    s_mul_i32 s72, s69, 12
    v_add_lshl_u32 v2, s72, v255, 7
    v_mov_b32 v3, s71
    v_cmp_gt_u32 vcc, K_END-CPF_BASE, v2
    s_nop 0
    s_and_b32 vcc_lo, vcc_lo, 0xfff
    s_mov_b32 vcc_hi, 0
    s_and_saveexec_b64 s[72:73], vcc
    s_cbranch_execz CPF_R
    v_add_co_u32 v2, vcc, s70, v2
    s_nop 1
    v_addc_co_u32 v3, vcc, 0, v3, vcc
    global_load_dword v191, v[2:3], off
CPF_R:
    s_mov_b64 exec, -1
NOCPF:
    s_mov_b32 s27, 0x20000
    s_mov_b32 s31, 0x20000
    s_lshr_b32 s96, s2, 3
    s_lshl_b32 s96, s96, 5
    s_and_b32 s97, s2, 3
    s_lshl_b32 s97, s97, 3
    s_add_u32 s96, s96, s97
    s_and_b32 s97, s2, 4
    s_lshl_b32 s97, s97, 8
    s_add_u32 s96, s96, s97
    s_add_u32 s96, s96, s40
    s_mul_i32 s97, s96, 1280
    s_lshl_b32 s96, s96, 4
    v_lshlrev_b32 v253, 2, v255
    s_mov_b32 s86, 2621440
    s_mov_b32 s87, 0x20000
    s_cmp_lt_u32 s69, 12
    s_cbranch_scc1 QA
    s_sub_u32 s70, s69, 12
    s_cmp_eq_u32 s68, 7
    s_cselect_b32 s77, 11, 5
    s_mov_b32 s71, 13108
    s_cselect_b32 s71, 5958, s71
    s_cselect_b32 s79, 2, 4
    s_lshl_b32 s42, s68, 2
    s_sub_u32 s42, s42, 16
    s_mul_i32 s72, s68, 3
    s_cmp_lt_u32 s68, 4
    s_cselect_b32 s77, 6, s77
    s_cselect_b32 s71, 10923, s71
    s_cselect_b32 s79, 3, s79
    s_cselect_b32 s42, s72, s42
    s_cselect_b32 s73, 0, 6
    s_mul_i32 s78, s70, s71
    s_lshr_b32 s78, s78, 16
    s_mul_i32 s72, s78, s77
    s_sub_u32 s76, s70, s72
    s_add_u32 s42, s42, s78
    s_lshl_b32 s72, s78, 1
    s_cmp_eq_u32 s68, 7
    s_cselect_b32 s73, s72, s73
    s_add_u32 s41, s76, s73
    s_cmp_eq_u32 s68, 7
    s_cselect_b32 s76, s41, s76
    s_cmp_eq_u32 s68, 3
    s_cselect_b32 s72, 13, 14
    s_cmp_eq_u32 s78, s79
    s_cselect_b32 s42, s72, s42
    v_lshrrev_b32 v236, 1, v255
    v_mul_u32_u24 v236, s77, v236
    v_add_u32 v236, s76, v236
    v_cmp_gt_u32 vcc, 64, v236
    v_mul_u32_u24 v236, 3456, v236
    v_and_b32 v237, 1, v255
    v_lshl_add_u32 v236, v237, 7, v236
    s_lshl_b32 s71, s42, 8
    v_add_u32 v236, s71, v236
    v_mov_b32 v237, 0x80000000
    v_cndmask_b32 v189, v237, v236, vcc
    s_bfe_u32 s69, s40, 0x10001
    s_lshl_b32 s71, s42, 1
    s_add_u32 s71, s71, s69
    s_cmp_lt_u32 s71, 27
    s_cselect_b32 s30, 2211840, 0
    s_cmp_lt_u32 s42, 14
    s_cselect_b32 s26, 2621440, 0
    s_waitcnt lgkmcnt(0)
    s_mov_b32 s24, s4
    s_mov_b32 s25, s5
    s_cmp_lt_u32 s40, 4
    s_cselect_b32 s28, s12, s14
    s_cselect_b32 s29, s13, s15
    s_mov_b32 s84, s4
    s_mov_b32 s85, s5
    buffer_load_dwordx4 v[196:199], v254, s[84:87], s97 offen
    buffer_load_dword v200, v253, s[84:87], s97 offen offset:1024
    s_and_b32 s68, s40, 3
    s_add_u32 s46, s68, 0
    s_mul_i32 s46, s46, 221184
    s_cmp_lt_u32 s68, 3
    s_cselect_b32 s46, s46, 2211840
    buffer_load_dword v191, v189, s[28:31], s46 offen
    s_branch GB
QA:
    s_cmp_ge_u32 s69, 6
    s_cselect_b32 s70, 1, 0
    s_and_b32 s71, s68, 3
    s_lshl_b32 s42, s71, 1
    s_add_u32 s42, s42, s70
    s_mul_i32 s70, s70, 6
    s_sub_u32 s41, s69, s70
    s_lshr_b32 s72, s68, 2
    s_mul_i32 s72, s72, 6
    s_add_u32 s41, s41, s72
    v_mul_u32_u24 v236, 7282, v255
    v_lshrrev_b32 v236, 16, v236
    v_mul_u32_u24 v237, 9, v236
    v_sub_u32 v237, v255, v237
    v_mul_u32_u24 v238, 21846, v237
    v_lshrrev_b32 v238, 16, v238
    v_mul_u32_u24 v238, 896, v238
    v_lshl_add_u32 v238, v237, 7, v238
    v_mul_u32_u24 v236, 12, v236
    v_add_u32 v236, s69, v236
    v_cmp_gt_u32 vcc, 64, v236
    v_mul_u32_u24 v236, 3840, v236
    s_mul_i32 s73, s71, 320
    s_and_b32 s73, s73, 0xffffff80
    v_add3_u32 v236, v236, v238, s73
    v_mov_b32 v237, 0x80000000
    v_cndmask_b32 v189, v237, v236, vcc
    s_mov_b32 s26, 2621440
    s_mov_b32 s30, 2457600
    s_waitcnt lgkmcnt(0)
    s_mov_b32 s24, s4
    s_mov_b32 s25, s5
    s_mov_b32 s28, s6
    s_mov_b32 s29, s7
    s_mov_b32 s84, s4
    s_mov_b32 s85, s5
    buffer_load_dwordx4 v[196:199], v254, s[84:87], s97 offen
    buffer_load_dword v200, v253, s[84:87], s97 offen offset:1024
    s_mov_b32 s68, s40
    s_add_u32 s46, s68, 0
    s_mul_i32 s46, s46, 245760
    s_cmp_lt_u32 s68, 3
    s_cselect_b32 s46, s46, 2457600
    buffer_load_dword v191, v189, s[28:31], s46 offen
    s_branch QKV
GB:
    v_lshrrev_b32 v236, 3, v255
    v_and_b32 v237, 7, v255
    v_and_b32 v238, 6, v236
    v_xor_b32 v237, v237, v238
    v_and_b32 v238, 4, v236
    v_add_u32 v236, v236, v238
    s_and_b32 s68, s40, 1
    s_lshl_b32 s69, s68, 4
    v_add_u32 v236, s69, v236
    v_mul_u32_u24 v236, 3456, v236
    v_lshl_add_u32 v236, v237, 4, v236
    s_bfe_u32 s69, s40, 0x10001
    s_lshl_b32 s70, s42, 8
    s_lshl_b32 s71, s69, 7
    s_add_u32 s70, s70, s71
    v_add_u32 v187, s70, v236
    v_add_u32 v188, 13824, v187
    s_lshr_b32 s74, s40, 2
    s_lshl_b32 s47, s74, 13
    s_lshl_b32 s70, s69, 12
    s_add_u32 s47, s47, s70
    s_lshl_b32 s70, s68, 10
    s_add_u32 s47, s47, s70
    s_add_u32 s47, s47, 73728
    s_add_u32 s48, s47, 2048
    s_mov_b32 s45, 110592
    v_lshrrev_b32 v236, 3, v255
    v_and_b32 v237, 7, v255
    v_lshrrev_b32 v238, 1, v236
    s_and_b32 s68, s40, 1
    s_lshl_b32 s69, s68, 2
    v_or_b32 v238, s69, v238
    v_xor_b32 v237, v237, v238
    s_mul_i32 s69, s41, 188
    s_lshl_b32 s70, s40, 3
    s_add_u32 s69, s69, s70
    s_sub_u32 s69, s69, 4
    v_add_u32 v236, s69, v236
    v_mul_i32_i24 v236, 1280, v236
    v_lshl_add_u32 v184, v237, 4, v236
    v_add_u32 v185, 81920, v184
    v_add_u32 v186, 163840, v184
    s_lshl_b32 s49, s40, 10
    s_cmp_eq_u32 s40, 0
    s_cselect_b32 s56, 0xffffff00, -1
    s_mov_b32 s57, -1
    s_mov_b32 s32, s22
    s_mov_b32 s33, s23
    s_mov_b32 s34, 32768
    s_mov_b32 s35, 0x20000
    s_add_u32 s36, s22, 3145728
    s_addc_u32 s37, s23, 0
    s_mov_b32 s38, 9699328
    s_mov_b32 s39, 0x20000
    s_add_u32 s52, s22, 65536
    s_addc_u32 s53, s23, 0
    s_mov_b32 s54, 3031040
    s_mov_b32 s55, 0x20000
    s_add_u32 s60, s22, 32768
    s_addc_u32 s61, s23, 0
    s_mov_b32 s62, 8192
    s_mov_b32 s63, 0x20000
    s_mov_b32 s64, s20
    s_mov_b32 s65, s21
    s_mov_b32 s66, 256
    s_mov_b32 s67, 0x20000
    v_mov_b32 v236, 0x3f803f80
    v_mov_b32 v237, 0x3f803f80
    v_mov_b32 v238, 0x3f803f80
    v_mov_b32 v239, 0x3f803f80
    s_mov_b64 exec, 0xff
    ds_write_b128 v254, v[236:239] offset:0
    ds_write_b128 v254, v[236:239] offset:24576
    ds_write_b128 v254, v[236:239] offset:49152
    s_mov_b64 exec, -1
    v_and_b32 v240, 15, v255
    v_lshrrev_b32 v241, 4, v255
    v_lshrrev_b32 v242, 1, v240
    v_xor_b32 v241, v241, v242
    v_lshlrev_b32 v241, 4, v241
    v_lshl_add_u32 v240, v240, 7, v241
    s_lshr_b32 s68, s40, 2
    s_mul_i32 s68, s68, 12288
    v_add_u32 v244, s68, v240
    v_xor_b32 v245, 64, v244
    s_and_b32 s68, s2, 7
    s_lshr_b32 s71, s2, 3
    s_lshl_b32 s90, s68, 2
    s_lshr_b32 s68, s71, 3
    s_add_u32 s90, s90, s68
    s_and_b32 s91, s71, 7
    s_mul_i32 s92, s40, 6
    s_add_u32 s92, s92, 20
    s_lshl_b32 s93, s40, 1
    s_sub_u32 s93, s93, 7
    s_add_u32 s95, s40, 68
    s_add_u32 s68, s40, 10
    s_cmp_lt_u32 s40, 6
    s_cselect_b32 s95, s95, s68
    s_add_u32 s50, s40, 18
    s_mul_i32 s94, s91, 74
    s_lshr_b32 s59, s40, 1
    s_sub_u32 s58, s2, 96
    s_lshl_b32 s58, s58, 2
    s_add_u32 s88, s58, s59
    s_mul_i32 s58, s88, 6554
    s_lshr_b32 s58, s58, 16
    s_mul_i32 s89, s58, 10
    s_sub_u32 s89, s88, s89
    s_sub_u32 s80, s58, 20
    s_lshl_b32 s80, s80, 5
    s_mul_i32 s81, s58, 40
    s_mul_i32 s82, s58, 160
    s_sub_u32 s82, s82, 2544
    s_cmp_lt_u32 s58, 16
    s_cselect_b32 s81, s81, s82
    s_cselect_b32 s83, 4, 40
    s_cmp_lt_u32 s58, 20
    s_cselect_b32 s80, s81, s80
    s_cselect_b32 s83, s83, 4
    s_cselect_b32 s81, 20, 16
    s_cselect_b32 s84, s8, s16
    s_cselect_b32 s85, s9, s17
    s_mov_b32 s86, 2211840
    s_cselect_b32 s86, 819200, s86
    s_mov_b32 s87, 0x20000
    s_and_b32 s82, s40, 1
    s_mul_i32 s88, s82, s83
    s_lshl_b32 s88, s88, 1
    s_add_u32 s80, s80, s88
    s_mul_i32 s80, s80, 1280
    s_lshl_b32 s88, s89, 7
    s_add_u32 s80, s80, s88
    s_mul_i32 s81, s81, 1280
    s_add_u32 s81, s81, s80
    v_lshrrev_b32 v224, 5, v255
    v_mul_u32_u24 v224, s83, v224
    v_bfe_u32 v225, v255, 3, 2
    v_add_u32 v224, v224, v225
    v_mul_u32_u24 v224, 1280, v224
    v_lshrrev_b32 v225, 3, v255
    v_and_b32 v225, 6, v225
    v_xor_b32 v225, v225, v255
    v_and_b32 v225, 7, v225
    v_lshl_add_u32 v224, v225, 4, v224
    s_lshl_b32 s59, s59, 12
    s_add_u32 s59, s59, 139264
    s_lshl_b32 s83, s82, 10
    s_add_u32 s83, s83, s59
    v_bfe_u32 v226, v255, 2, 3
    v_lshrrev_b32 v225, 5, v255
    v_lshlrev_b32 v225, 10, v225
    v_lshl_add_u32 v225, v226, 7, v225
    v_and_b32 v227, 3, v255
    v_lshl_add_u32 v225, v227, 3, v225
    v_lshrrev_b32 v226, 1, v226
    s_lshl_b32 s82, s82, 1
    v_xor_b32 v226, s82, v226
    v_lshl_add_u32 v225, v226, 5, v225
    v_add_u32 v225, s59, v225
    v_xor_b32 v226, 32, v225
    s_lshl_b32 s89, s89, 2
    s_add_u32 s89, s89, s82
    s_mul_i32 s82, s58, 5
    s_mul_i32 s88, s89, 13108
    s_lshr_b32 s88, s88, 16
    s_mul_i32 s88, s88, 365
    s_add_u32 s88, s88, s89
    s_add_u32 s88, s88, s82
    s_lshl_b32 s88, s88, 10
    s_cmp_lt_u32 s58, 74
    s_cselect_b32 s76, s88, 3031040
    s_add_u32 s89, s89, 1
    s_mul_i32 s88, s89, 13108
    s_lshr_b32 s88, s88, 16
    s_mul_i32 s88, s88, 365
    s_add_u32 s88, s88, s89
    s_add_u32 s88, s88, s82
    s_lshl_b32 s88, s88, 10
    s_cmp_lt_u32 s58, 74
    s_cselect_b32 s77, s88, 3031040
    v_bfe_u32 v236, v255, 2, 3
    v_lshrrev_b32 v237, 5, v255
    v_lshlrev_b32 v237, 10, v237
    v_lshl_add_u32 v237, v236, 7, v237
    v_and_b32 v238, 3, v255
    v_lshl_add_u32 v237, v238, 3, v237
    v_lshrrev_b32 v236, 1, v236
    s_and_b32 s68, s40, 1
    s_lshl_b32 s68, s68, 1
    v_xor_b32 v236, s68, v236
    v_lshl_add_u32 v237, v236, 5, v237
    s_bfe_u32 s68, s40, 0x10001
    s_lshl_b32 s68, s68, 12
    s_add_u32 s68, s68, 73728
    v_add_u32 v246, s68, v237
    v_xor_b32 v247, 32, v246
    s_add_u32 m0, s83, 0
    s_nop 0
    buffer_load_dwordx4 v224, s[84:87], s80 offen lds
    s_add_u32 m0, s83, 2048
    s_nop 0
    buffer_load_dwordx4 v224, s[84:87], s81 offen lds
    s_add_u32 m0, s47, 0
    s_mul_i32 s44, s45, 0
    buffer_load_dwordx4 v187, s[28:31], s44 offen lds
    s_add_u32 m0, s48, 0
    s_mul_i32 s44, s45, 0
    buffer_load_dwordx4 v188, s[28:31], s44 offen lds
    s_add_u32 m0, s49, 0
    s_movk_i32 s46, 0
    s_mov_b64 exec, s[56:57]
    buffer_load_dwordx4 v184, s[24:27], s46 offen lds
    s_mov_b64 exec, -1
    s_add_u32 m0, s49, 8192
    s_movk_i32 s46, 0
    buffer_load_dwordx4 v185, s[24:27], s46 offen lds
    s_add_u32 m0, s49, 16384
    s_movk_i32 s46, 0
    buffer_load_dwordx4 v186, s[24:27], s46 offen lds
    s_barrier
    s_add_u32 m0, s47, 16384
    s_mul_i32 s44, s45, 1
    buffer_load_dwordx4 v187, s[28:31], s44 offen lds
    s_add_u32 m0, s48, 16384
    s_mul_i32 s44, s45, 1
    buffer_load_dwordx4 v188, s[28:31], s44 offen lds
    s_waitcnt vmcnt(10)
    v_lshlrev_b32 v202, 16, v196
    v_and_b32 v203, 0xffff0000, v196
    v_lshlrev_b32 v204, 16, v197
    v_and_b32 v205, 0xffff0000, v197
    v_lshlrev_b32 v206, 16, v198
    v_and_b32 v207, 0xffff0000, v198
    v_lshlrev_b32 v208, 16, v199
    v_and_b32 v209, 0xffff0000, v199
    v_lshlrev_b32 v210, 16, v200
    v_and_b32 v211, 0xffff0000, v200
    v_readfirstlane_b32 s78, v202
    v_readfirstlane_b32 s79, v202
    s_nop 1
    v_pk_add_f32 v[202:203], v[202:203], s[78:79] neg_lo:[0,1] neg_hi:[0,1]
    v_pk_add_f32 v[204:205], v[204:205], s[78:79] neg_lo:[0,1] neg_hi:[0,1]
    v_pk_add_f32 v[206:207], v[206:207], s[78:79] neg_lo:[0,1] neg_hi:[0,1]
    v_pk_add_f32 v[208:209], v[208:209], s[78:79] neg_lo:[0,1] neg_hi:[0,1]
    v_pk_add_f32 v[210:211], v[210:211], s[78:79] neg_lo:[0,1] neg_hi:[0,1]
    v_pk_add_f32 v[212:213], v[202:203], v[204:205]
    v_pk_mul_f32 v[214:215], v[202:203], v[202:203]
    v_pk_fma_f32 v[214:215], v[204:205], v[204:205], v[214:215]
    v_pk_fma_f32 v[214:215], v[206:207], v[206:207], v[214:215]
    v_pk_add_f32 v[212:213], v[212:213], v[206:207]
    v_pk_fma_f32 v[214:215], v[208:209], v[208:209], v[214:215]
    v_pk_add_f32 v[212:213], v[212:213], v[208:209]
    v_pk_fma_f32 v[214:215], v[210:211], v[210:211], v[214:215]
    v_pk_add_f32 v[212:213], v[212:213], v[210:211]
    v_add_f32 v212, v212, v213
    v_add_f32 v214, v214, v215
    s_nop 1
    v_permlane32_swap_b32 v212, v214
    v_add_f32 v212, v212, v214
    s_nop 1
    v_add_f32_dpp v212, v212, v212 quad_perm:[1,0,3,2] row_mask:0xf bank_mask:0xf
    s_nop 1
    v_add_f32_dpp v212, v212, v212 quad_perm:[2,3,0,1] row_mask:0xf bank_mask:0xf
    s_nop 1
    v_add_f32_dpp v212, v212, v212 row_half_mirror row_mask:0xf bank_mask:0xf
    s_nop 1
    v_add_f32_dpp v212, v212, v212 row_mirror row_mask:0xf bank_mask:0xf
    v_mov_b32 v201, v212
    s_nop 1
    v_permlane16_swap_b32 v212, v201
    v_add_f32 v212, v212, v201
    v_mul_f32 v212, 0x3acccccd, v212
    s_nop 0
    v_readlane_b32 s79, v212, 32
    s_nop 1
    v_fma_f32 v214, -v212, v212, s79
    v_add_f32 v212, s78, v212
    v_max_f32 v214, 0, v214
    v_cvt_pk_bf16_f32 v212, v212, v212
    v_and_b32 v212, 0xffff0000, v212
    v_cvt_pk_bf16_f32 v214, v214, v214
    v_and_b32 v214, 0xffff0000, v214
    v_add_f32 v214, 0x3727c5ac, v214
    v_cvt_pk_bf16_f32 v214, v214, v214
    v_and_b32 v214, 0xffff0000, v214
    v_sqrt_f32 v214, v214
    s_nop 0
    v_cvt_pk_bf16_f32 v214, v214, v214
    v_and_b32 v214, 0xffff0000, v214
    v_rcp_f32 v213, v214
    v_mul_f32 v215, v214, v214
    v_mul_f32 v214, 0xbfb8aa3b, v213
    s_waitcnt vmcnt(2) lgkmcnt(0)
    s_barrier
    ds_read_b64_tr_b16 v[160:161], v246 offset:0
    s_add_u32 m0, s47, 32768
    s_mul_i32 s44, s45, 2
    buffer_load_dwordx4 v187, s[28:31], s44 offen lds
    ds_read_b128 v[136:139], v244 offset:0
    ds_read_b64_tr_b16 v[162:163], v246 offset:2048
    ds_read_b128 v[140:143], v244 offset:2048
    s_add_u32 m0, s48, 32768
    s_mul_i32 s44, s45, 2
    buffer_load_dwordx4 v188, s[28:31], s44 offen lds
    ds_read_b64_tr_b16 v[164:165], v247 offset:0
    ds_read_b128 v[144:147], v244 offset:4096
    s_add_u32 m0, s49, 24576
    s_movk_i32 s46, 128
    s_mov_b64 exec, s[56:57]
    buffer_load_dwordx4 v184, s[24:27], s46 offen lds
    s_mov_b64 exec, -1
    ds_read_b64_tr_b16 v[166:167], v247 offset:2048
    ds_read_b64_tr_b16 v[168:169], v246 offset:8192
    s_add_u32 m0, s49, 32768
    s_movk_i32 s46, 128
    buffer_load_dwordx4 v185, s[24:27], s46 offen lds
    ds_read_b128 v[148:151], v244 offset:6144
    ds_read_b64_tr_b16 v[170:171], v246 offset:10240
    ds_read_b128 v[152:155], v244 offset:8192
    s_add_u32 m0, s49, 40960
    s_movk_i32 s46, 128
    buffer_load_dwordx4 v186, s[24:27], s46 offen lds
    ds_read_b64_tr_b16 v[172:173], v247 offset:8192
    ds_read_b128 v[156:159], v244 offset:10240
    s_xor_b32 s68, s2, 248
    s_or_b32 s68, s68, s40
    s_cmp_eq_u32 s68, 0
    s_cbranch_scc0 SK_3
    v_lshlrev_b32 v250, 7, v255
    v_mov_b32 v252, 0
    buffer_store_dword v252, v250, s[60:63], 0 offen sc1
SK_3:
    ds_read_b64_tr_b16 v[174:175], v247 offset:10240
    s_waitcnt vmcnt(5) lgkmcnt(0)
    s_barrier
    v_mfma_f32_16x16x32_bf16 v[0:3], v[160:163], v[136:139], 0
    ds_read_b64_tr_b16 v[120:121], v246 offset:16384
    ds_read_b128 v[96:99], v245 offset:0
    v_mfma_f32_16x16x32_bf16 v[16:19], v[160:163], v[140:143], 0
    s_add_u32 m0, s47, 49152
    s_mul_i32 s44, s45, 3
    buffer_load_dwordx4 v187, s[28:31], s44 offen lds
    v_mfma_f32_16x16x32_bf16 v[32:35], v[160:163], v[144:147], 0
    ds_read_b64_tr_b16 v[216:217], v225 offset:0
    v_mfma_f32_16x16x32_bf16 v[48:51], v[160:163], v[148:151], 0
    ds_read_b64_tr_b16 v[122:123], v246 offset:18432
    v_mfma_f32_16x16x32_bf16 v[64:67], v[160:163], v[152:155], 0
    ds_read_b128 v[100:103], v245 offset:2048
    v_mfma_f32_16x16x32_bf16 v[80:83], v[160:163], v[156:159], 0
    ds_read_b64_tr_b16 v[124:125], v247 offset:16384
    ds_read_b128 v[104:107], v245 offset:4096
    v_mfma_f32_16x16x32_bf16 v[84:87], v[164:167], v[156:159], 0
    ds_read_b64_tr_b16 v[126:127], v247 offset:18432
    v_mfma_f32_16x16x32_bf16 v[68:71], v[164:167], v[152:155], 0
    s_add_u32 m0, s48, 49152
    s_mul_i32 s44, s45, 3
    buffer_load_dwordx4 v188, s[28:31], s44 offen lds
    v_mfma_f32_16x16x32_bf16 v[52:55], v[164:167], v[148:151], 0
    ds_read_b64_tr_b16 v[218:219], v225 offset:2048
    v_mfma_f32_16x16x32_bf16 v[36:39], v[164:167], v[144:147], 0
    ds_read_b64_tr_b16 v[128:129], v246 offset:24576
    v_mfma_f32_16x16x32_bf16 v[20:23], v[164:167], v[140:143], 0
    ds_read_b128 v[108:111], v245 offset:6144
    v_mfma_f32_16x16x32_bf16 v[4:7], v[164:167], v[136:139], 0
    ds_read_b64_tr_b16 v[130:131], v246 offset:26624
    ds_read_b128 v[112:115], v245 offset:8192
    v_mfma_f32_16x16x32_bf16 v[8:11], v[168:171], v[136:139], 0
    s_add_u32 m0, s49, 49152
    s_movk_i32 s46, 256
    s_mov_b64 exec, s[56:57]
    buffer_load_dwordx4 v184, s[24:27], s46 offen lds
    s_mov_b64 exec, -1
    v_mfma_f32_16x16x32_bf16 v[24:27], v[168:171], v[140:143], 0
    ds_read_b64_tr_b16 v[220:221], v226 offset:0
    v_mfma_f32_16x16x32_bf16 v[40:43], v[168:171], v[144:147], 0
    ds_read_b64_tr_b16 v[132:133], v247 offset:24576
    v_mfma_f32_16x16x32_bf16 v[56:59], v[168:171], v[148:151], 0
    ds_read_b128 v[116:119], v245 offset:10240
    v_mfma_f32_16x16x32_bf16 v[72:75], v[168:171], v[152:155], 0
    ds_read_b64_tr_b16 v[134:135], v247 offset:26624
    v_mfma_f32_16x16x32_bf16 v[88:91], v[168:171], v[156:159], 0
    v_mfma_f32_16x16x32_bf16 v[92:95], v[172:175], v[156:159], 0
    s_add_u32 m0, s49, 57344
    s_movk_i32 s46, 256
    buffer_load_dwordx4 v185, s[24:27], s46 offen lds
    v_mfma_f32_16x16x32_bf16 v[76:79], v[172:175], v[152:155], 0
    ds_read_b64_tr_b16 v[222:223], v226 offset:2048
    v_mfma_f32_16x16x32_bf16 v[60:63], v[172:175], v[148:151], 0
    v_mfma_f32_16x16x32_bf16 v[44:47], v[172:175], v[144:147], 0
    v_mfma_f32_16x16x32_bf16 v[28:31], v[172:175], v[140:143], 0
    s_and_b32 s68, s40, 3
    s_add_u32 s46, s68, 3
    s_mul_i32 s46, s46, 221184
    s_cmp_lt_u32 s68, 2
    s_cselect_b32 s46, s46, 2211840
    buffer_load_dword v191, v189, s[28:31], s46 offen
    v_mfma_f32_16x16x32_bf16 v[12:15], v[172:175], v[136:139], 0
    s_waitcnt vmcnt(5) lgkmcnt(0)
    s_barrier
    v_mfma_f32_16x16x32_bf16 v[0:3], v[120:123], v[96:99], v[0:3]
    ds_read_b64_tr_b16 v[160:161], v246 offset:32768
    ds_read_b128 v[136:139], v244 offset:24576
    v_mfma_f32_16x16x32_bf16 v[16:19], v[120:123], v[100:103], v[16:19]
    s_add_u32 m0, s47, 65536
    s_mul_i32 s44, s45, 4
    buffer_load_dwordx4 v187, s[28:31], s44 offen lds
    v_mfma_f32_16x16x32_bf16 v[32:35], v[120:123], v[104:107], v[32:35]
    ds_read_b64_tr_b16 v[162:163], v246 offset:34816
    v_mfma_f32_16x16x32_bf16 v[48:51], v[120:123], v[108:111], v[48:51]
    ds_read_b128 v[140:143], v244 offset:26624
    v_mfma_f32_16x16x32_bf16 v[64:67], v[120:123], v[112:115], v[64:67]
    ds_read_b64_tr_b16 v[164:165], v247 offset:32768
    v_mfma_f32_16x16x32_bf16 v[80:83], v[120:123], v[116:119], v[80:83]
    s_mov_b64 exec, 1
    buffer_store_dwordx4 v[212:215], off, s[32:35], s96 sc1
    s_mov_b64 exec, -1
    v_mfma_f32_16x16x32_bf16 v[84:87], v[124:127], v[116:119], v[84:87]
    ds_read_b128 v[144:147], v244 offset:28672
    v_mfma_f32_16x16x32_bf16 v[68:71], v[124:127], v[112:115], v[68:71]
    ds_read_b64_tr_b16 v[166:167], v247 offset:34816
    v_mfma_f32_16x16x32_bf16 v[52:55], v[124:127], v[108:111], v[52:55]
    s_add_u32 m0, s48, 65536
    s_mul_i32 s44, s45, 4
    buffer_load_dwordx4 v188, s[28:31], s44 offen lds
    v_mfma_f32_16x16x32_bf16 v[36:39], v[124:127], v[104:107], v[36:39]
    ds_read_b64_tr_b16 v[168:169], v246 offset:40960
    v_mfma_f32_16x16x32_bf16 v[20:23], v[124:127], v[100:103], v[20:23]
    ds_read_b128 v[148:151], v244 offset:30720
    v_mfma_f32_16x16x32_bf16 v[4:7], v[124:127], v[96:99], v[4:7]
    ds_read_b64_tr_b16 v[170:171], v246 offset:43008
    v_mfma_f32_16x16x32_bf16 v[8:11], v[128:131], v[96:99], v[8:11]
    ds_read_b128 v[152:155], v244 offset:32768
    v_mfma_f32_16x16x32_bf16 v[24:27], v[128:131], v[100:103], v[24:27]
    s_add_u32 m0, s49, 65536
    s_movk_i32 s46, 256
    buffer_load_dwordx4 v186, s[24:27], s46 offen lds
    v_mfma_f32_16x16x32_bf16 v[40:43], v[128:131], v[104:107], v[40:43]
    ds_read_b64_tr_b16 v[172:173], v247 offset:40960
    v_mfma_f32_16x16x32_bf16 v[56:59], v[128:131], v[108:111], v[56:59]
    ds_read_b128 v[156:159], v244 offset:34816
    v_mfma_f32_16x16x32_bf16 v[72:75], v[128:131], v[112:115], v[72:75]
    ds_read_b64_tr_b16 v[174:175], v247 offset:43008
    v_mfma_f32_16x16x32_bf16 v[88:91], v[128:131], v[116:119], v[88:91]
    buffer_store_dwordx4 v[216:219], v254, s[52:55], s76 offen sc1
    v_mfma_f32_16x16x32_bf16 v[92:95], v[132:135], v[116:119], v[92:95]
    v_mfma_f32_16x16x32_bf16 v[76:79], v[132:135], v[112:115], v[76:79]
    v_mfma_f32_16x16x32_bf16 v[60:63], v[132:135], v[108:111], v[60:63]
    s_add_u32 m0, s47, 0
    s_mul_i32 s44, s45, 5
    buffer_load_dwordx4 v187, s[28:31], s44 offen lds
    v_mfma_f32_16x16x32_bf16 v[44:47], v[132:135], v[104:107], v[44:47]
    v_mfma_f32_16x16x32_bf16 v[28:31], v[132:135], v[100:103], v[28:31]
    v_mfma_f32_16x16x32_bf16 v[12:15], v[132:135], v[96:99], v[12:15]
    s_waitcnt vmcnt(9) lgkmcnt(0)
    s_barrier
    v_mfma_f32_16x16x32_bf16 v[0:3], v[160:163], v[136:139], v[0:3]
    v_add_u32 v246, 49152, v246
    v_add_u32 v247, 49152, v247
    ds_read_b64_tr_b16 v[120:121], v246 offset:0
    v_mfma_f32_16x16x32_bf16 v[16:19], v[160:163], v[140:143], v[16:19]
    ds_read_b128 v[96:99], v245 offset:24576
    v_mfma_f32_16x16x32_bf16 v[32:35], v[160:163], v[144:147], v[32:35]
    s_add_u32 m0, s48, 0
    s_mul_i32 s44, s45, 5
    buffer_load_dwordx4 v188, s[28:31], s44 offen lds
    v_mfma_f32_16x16x32_bf16 v[48:51], v[160:163], v[148:151], v[48:51]
    ds_read_b64_tr_b16 v[122:123], v246 offset:2048
    v_mfma_f32_16x16x32_bf16 v[64:67], v[160:163], v[152:155], v[64:67]
    ds_read_b128 v[100:103], v245 offset:26624
    v_mfma_f32_16x16x32_bf16 v[80:83], v[160:163], v[156:159], v[80:83]
    ds_read_b64_tr_b16 v[124:125], v247 offset:0
    v_mfma_f32_16x16x32_bf16 v[84:87], v[164:167], v[156:159], v[84:87]
    ds_read_b128 v[104:107], v245 offset:28672
    v_mfma_f32_16x16x32_bf16 v[68:71], v[164:167], v[152:155], v[68:71]
    ds_read_b64_tr_b16 v[126:127], v247 offset:2048
    v_mfma_f32_16x16x32_bf16 v[52:55], v[164:167], v[148:151], v[52:55]
    s_add_u32 m0, s47, 16384
    s_mul_i32 s44, s45, 6
    buffer_load_dwordx4 v187, s[28:31], s44 offen lds
    v_mfma_f32_16x16x32_bf16 v[36:39], v[164:167], v[144:147], v[36:39]
    ds_read_b64_tr_b16 v[128:129], v246 offset:8192
    v_mfma_f32_16x16x32_bf16 v[20:23], v[164:167], v[140:143], v[20:23]
    ds_read_b128 v[108:111], v245 offset:30720
    v_mfma_f32_16x16x32_bf16 v[4:7], v[164:167], v[136:139], v[4:7]
    buffer_store_dwordx4 v[220:223], v254, s[52:55], s77 offen sc1
    v_mfma_f32_16x16x32_bf16 v[8:11], v[168:171], v[136:139], v[8:11]
    ds_read_b64_tr_b16 v[130:131], v246 offset:10240
    v_mfma_f32_16x16x32_bf16 v[24:27], v[168:171], v[140:143], v[24:27]
    ds_read_b128 v[112:115], v245 offset:32768
    v_mfma_f32_16x16x32_bf16 v[40:43], v[168:171], v[144:147], v[40:43]
    s_add_u32 m0, s48, 16384
    s_mul_i32 s44, s45, 6
    buffer_load_dwordx4 v188, s[28:31], s44 offen lds
    v_mfma_f32_16x16x32_bf16 v[56:59], v[168:171], v[148:151], v[56:59]
    ds_read_b64_tr_b16 v[132:133], v247 offset:8192
    v_mfma_f32_16x16x32_bf16 v[72:75], v[168:171], v[152:155], v[72:75]
    ds_read_b128 v[116:119], v245 offset:34816
    v_mfma_f32_16x16x32_bf16 v[88:91], v[168:171], v[156:159], v[88:91]
    ds_read_b64_tr_b16 v[134:135], v247 offset:10240
    v_mfma_f32_16x16x32_bf16 v[92:95], v[172:175], v[156:159], v[92:95]
    v_mfma_f32_16x16x32_bf16 v[76:79], v[172:175], v[152:155], v[76:79]
    v_mfma_f32_16x16x32_bf16 v[60:63], v[172:175], v[148:151], v[60:63]
    s_add_u32 m0, s49, 0
    s_movk_i32 s46, 384
    s_mov_b64 exec, s[56:57]
    buffer_load_dwordx4 v184, s[24:27], s46 offen lds
    s_mov_b64 exec, -1
    v_mfma_f32_16x16x32_bf16 v[44:47], v[172:175], v[144:147], v[44:47]
    v_mfma_f32_16x16x32_bf16 v[28:31], v[172:175], v[140:143], v[28:31]
    v_mfma_f32_16x16x32_bf16 v[12:15], v[172:175], v[136:139], v[12:15]
    s_waitcnt vmcnt(7) lgkmcnt(0)
    s_barrier
    v_mfma_f32_16x16x32_bf16 v[0:3], v[120:123], v[96:99], v[0:3]
    ds_read_b64_tr_b16 v[160:161], v246 offset:16384
    v_mfma_f32_16x16x32_bf16 v[16:19], v[120:123], v[100:103], v[16:19]
    ds_read_b128 v[136:139], v244 offset:49152
    v_mfma_f32_16x16x32_bf16 v[32:35], v[120:123], v[104:107], v[32:35]
    s_add_u32 m0, s49, 8192
    s_movk_i32 s46, 384
    buffer_load_dwordx4 v185, s[24:27], s46 offen lds
    v_mfma_f32_16x16x32_bf16 v[48:51], v[120:123], v[108:111], v[48:51]
    ds_read_b64_tr_b16 v[162:163], v246 offset:18432
    v_mfma_f32_16x16x32_bf16 v[64:67], v[120:123], v[112:115], v[64:67]
    ds_read_b128 v[140:143], v244 offset:51200
    v_mfma_f32_16x16x32_bf16 v[80:83], v[120:123], v[116:119], v[80:83]
    ds_read_b64_tr_b16 v[164:165], v247 offset:16384
    v_mfma_f32_16x16x32_bf16 v[84:87], v[124:127], v[116:119], v[84:87]
    ds_read_b128 v[144:147], v244 offset:53248
    v_mfma_f32_16x16x32_bf16 v[68:71], v[124:127], v[112:115], v[68:71]
    ds_read_b64_tr_b16 v[166:167], v247 offset:18432
    v_mfma_f32_16x16x32_bf16 v[52:55], v[124:127], v[108:111], v[52:55]
    s_add_u32 m0, s49, 16384
    s_movk_i32 s46, 384
    buffer_load_dwordx4 v186, s[24:27], s46 offen lds
    v_mfma_f32_16x16x32_bf16 v[36:39], v[124:127], v[104:107], v[36:39]
    ds_read_b64_tr_b16 v[168:169], v246 offset:24576
    v_mfma_f32_16x16x32_bf16 v[20:23], v[124:127], v[100:103], v[20:23]
    ds_read_b128 v[148:151], v244 offset:55296
    v_mfma_f32_16x16x32_bf16 v[4:7], v[124:127], v[96:99], v[4:7]
    ds_read_b64_tr_b16 v[170:171], v246 offset:26624
    v_mfma_f32_16x16x32_bf16 v[8:11], v[128:131], v[96:99], v[8:11]
    ds_read_b128 v[152:155], v244 offset:57344
    v_mfma_f32_16x16x32_bf16 v[24:27], v[128:131], v[100:103], v[24:27]
    s_add_u32 m0, s47, 32768
    s_mul_i32 s44, s45, 7
    buffer_load_dwordx4 v187, s[28:31], s44 offen lds
    v_mfma_f32_16x16x32_bf16 v[40:43], v[128:131], v[104:107], v[40:43]
    ds_read_b64_tr_b16 v[172:173], v247 offset:24576
    v_mfma_f32_16x16x32_bf16 v[56:59], v[128:131], v[108:111], v[56:59]
    ds_read_b128 v[156:159], v244 offset:59392
    v_mfma_f32_16x16x32_bf16 v[72:75], v[128:131], v[112:115], v[72:75]
    ds_read_b64_tr_b16 v[174:175], v247 offset:26624
    v_mfma_f32_16x16x32_bf16 v[88:91], v[128:131], v[116:119], v[88:91]
    v_mfma_f32_16x16x32_bf16 v[92:95], v[132:135], v[116:119], v[92:95]
    v_mfma_f32_16x16x32_bf16 v[76:79], v[132:135], v[112:115], v[76:79]
    s_add_u32 m0, s48, 32768
    s_mul_i32 s44, s45, 7
    buffer_load_dwordx4 v188, s[28:31], s44 offen lds
    v_mfma_f32_16x16x32_bf16 v[60:63], v[132:135], v[108:111], v[60:63]
    v_mfma_f32_16x16x32_bf16 v[44:47], v[132:135], v[104:107], v[44:47]
    v_mfma_f32_16x16x32_bf16 v[28:31], v[132:135], v[100:103], v[28:31]
    v_mfma_f32_16x16x32_bf16 v[12:15], v[132:135], v[96:99], v[12:15]
    s_waitcnt vmcnt(6) lgkmcnt(0)
    s_barrier
    v_mfma_f32_16x16x32_bf16 v[0:3], v[160:163], v[136:139], v[0:3]
    v_subrev_u32 v246, 49152, v246
    v_subrev_u32 v247, 49152, v247
    ds_read_b64_tr_b16 v[120:121], v246 offset:0
    ds_read_b128 v[96:99], v245 offset:49152
    v_mfma_f32_16x16x32_bf16 v[16:19], v[160:163], v[140:143], v[16:19]
    s_add_u32 m0, s47, 49152
    s_mul_i32 s44, s45, 8
    buffer_load_dwordx4 v187, s[28:31], s44 offen lds
    v_mfma_f32_16x16x32_bf16 v[32:35], v[160:163], v[144:147], v[32:35]
    ds_read_b64_tr_b16 v[122:123], v246 offset:2048
    v_mfma_f32_16x16x32_bf16 v[48:51], v[160:163], v[148:151], v[48:51]
    ds_read_b128 v[100:103], v245 offset:51200
    v_mfma_f32_16x16x32_bf16 v[64:67], v[160:163], v[152:155], v[64:67]
    ds_read_b64_tr_b16 v[124:125], v247 offset:0
    v_mfma_f32_16x16x32_bf16 v[80:83], v[160:163], v[156:159], v[80:83]
    ds_read_b128 v[104:107], v245 offset:53248
    v_mfma_f32_16x16x32_bf16 v[84:87], v[164:167], v[156:159], v[84:87]
    ds_read_b64_tr_b16 v[126:127], v247 offset:2048
    v_mfma_f32_16x16x32_bf16 v[68:71], v[164:167], v[152:155], v[68:71]
    s_add_u32 m0, s48, 49152
    s_mul_i32 s44, s45, 8
    buffer_load_dwordx4 v188, s[28:31], s44 offen lds
    v_mfma_f32_16x16x32_bf16 v[52:55], v[164:167], v[148:151], v[52:55]
    ds_read_b64_tr_b16 v[128:129], v246 offset:8192
    v_mfma_f32_16x16x32_bf16 v[36:39], v[164:167], v[144:147], v[36:39]
    ds_read_b128 v[108:111], v245 offset:55296
    v_mfma_f32_16x16x32_bf16 v[20:23], v[164:167], v[140:143], v[20:23]
    s_cmp_eq_u32 s40, 0
    s_cbranch_scc0 SK_8
    s_and_b32 s68, s2, 15
    s_lshl_b32 s68, s68, 4
    v_mov_b32 v252, 1
    s_mov_b64 exec, 1
    buffer_atomic_add v252, off, s[64:67], s68 sc1
    s_mov_b64 exec, -1
SK_8:
    v_mfma_f32_16x16x32_bf16 v[4:7], v[164:167], v[136:139], v[4:7]
    ds_read_b64_tr_b16 v[130:131], v246 offset:10240
    v_mfma_f32_16x16x32_bf16 v[8:11], v[168:171], v[136:139], v[8:11]
    ds_read_b128 v[112:115], v245 offset:57344
    v_mfma_f32_16x16x32_bf16 v[24:27], v[168:171], v[140:143], v[24:27]
    s_add_u32 m0, s49, 24576
    s_movk_i32 s46, 512
    s_mov_b64 exec, s[56:57]
    buffer_load_dwordx4 v184, s[24:27], s46 offen lds
    s_mov_b64 exec, -1
    v_mfma_f32_16x16x32_bf16 v[40:43], v[168:171], v[144:147], v[40:43]
    ds_read_b64_tr_b16 v[132:133], v247 offset:8192
    v_mfma_f32_16x16x32_bf16 v[56:59], v[168:171], v[148:151], v[56:59]
    ds_read_b128 v[116:119], v245 offset:59392
    v_mfma_f32_16x16x32_bf16 v[72:75], v[168:171], v[152:155], v[72:75]
    ds_read_b64_tr_b16 v[134:135], v247 offset:10240
    v_mfma_f32_16x16x32_bf16 v[88:91], v[168:171], v[156:159], v[88:91]
    v_mfma_f32_16x16x32_bf16 v[92:95], v[172:175], v[156:159], v[92:95]
    v_mfma_f32_16x16x32_bf16 v[76:79], v[172:175], v[152:155], v[76:79]
    s_add_u32 m0, s49, 32768
    s_movk_i32 s46, 512
    buffer_load_dwordx4 v185, s[24:27], s46 offen lds
    v_mfma_f32_16x16x32_bf16 v[60:63], v[172:175], v[148:151], v[60:63]
    v_mfma_f32_16x16x32_bf16 v[44:47], v[172:175], v[144:147], v[44:47]
    v_mfma_f32_16x16x32_bf16 v[28:31], v[172:175], v[140:143], v[28:31]
    s_and_b32 s68, s40, 3
    s_add_u32 s46, s68, 5
    s_mul_i32 s46, s46, 221184
    s_cmp_lt_u32 s68, 2
    s_cselect_b32 s46, s46, 2211840
    buffer_load_dword v191, v189, s[28:31], s46 offen
    v_mfma_f32_16x16x32_bf16 v[12:15], v[172:175], v[136:139], v[12:15]
    s_waitcnt vmcnt(7) lgkmcnt(0)
    s_barrier
    v_mfma_f32_16x16x32_bf16 v[0:3], v[120:123], v[96:99], v[0:3]
    ds_read_b64_tr_b16 v[160:161], v246 offset:16384
    v_mfma_f32_16x16x32_bf16 v[16:19], v[120:123], v[100:103], v[16:19]
    ds_read_b128 v[136:139], v244 offset:0
    v_mfma_f32_16x16x32_bf16 v[32:35], v[120:123], v[104:107], v[32:35]
    s_add_u32 m0, s49, 40960
    s_movk_i32 s46, 512
    buffer_load_dwordx4 v186, s[24:27], s46 offen lds
    v_mfma_f32_16x16x32_bf16 v[48:51], v[120:123], v[108:111], v[48:51]
    ds_read_b64_tr_b16 v[162:163], v246 offset:18432
    v_mfma_f32_16x16x32_bf16 v[64:67], v[120:123], v[112:115], v[64:67]
    ds_read_b128 v[140:143], v244 offset:2048
    v_mfma_f32_16x16x32_bf16 v[80:83], v[120:123], v[116:119], v[80:83]
    ds_read_b64_tr_b16 v[164:165], v247 offset:16384
    v_mfma_f32_16x16x32_bf16 v[84:87], v[124:127], v[116:119], v[84:87]
    ds_read_b128 v[144:147], v244 offset:4096
    v_mfma_f32_16x16x32_bf16 v[68:71], v[124:127], v[112:115], v[68:71]
    ds_read_b64_tr_b16 v[166:167], v247 offset:18432
    v_mfma_f32_16x16x32_bf16 v[52:55], v[124:127], v[108:111], v[52:55]
    s_add_u32 m0, s47, 65536
    s_mul_i32 s44, s45, 9
    buffer_load_dwordx4 v187, s[28:31], s44 offen lds
    v_mfma_f32_16x16x32_bf16 v[36:39], v[124:127], v[104:107], v[36:39]
    ds_read_b64_tr_b16 v[168:169], v246 offset:24576
    v_mfma_f32_16x16x32_bf16 v[20:23], v[124:127], v[100:103], v[20:23]
    ds_read_b128 v[148:151], v244 offset:6144
    v_mfma_f32_16x16x32_bf16 v[4:7], v[124:127], v[96:99], v[4:7]
    ds_read_b64_tr_b16 v[170:171], v246 offset:26624
    v_mfma_f32_16x16x32_bf16 v[8:11], v[128:131], v[96:99], v[8:11]
    ds_read_b128 v[152:155], v244 offset:8192
    v_mfma_f32_16x16x32_bf16 v[24:27], v[128:131], v[100:103], v[24:27]
    s_add_u32 m0, s48, 65536
    s_mul_i32 s44, s45, 9
    buffer_load_dwordx4 v188, s[28:31], s44 offen lds
    v_mfma_f32_16x16x32_bf16 v[40:43], v[128:131], v[104:107], v[40:43]
    ds_read_b64_tr_b16 v[172:173], v247 offset:24576
    v_mfma_f32_16x16x32_bf16 v[56:59], v[128:131], v[108:111], v[56:59]
    ds_read_b128 v[156:159], v244 offset:10240
    v_mfma_f32_16x16x32_bf16 v[72:75], v[128:131], v[112:115], v[72:75]
    ds_read_b64_tr_b16 v[174:175], v247 offset:26624
    v_mfma_f32_16x16x32_bf16 v[88:91], v[128:131], v[116:119], v[88:91]
    v_mfma_f32_16x16x32_bf16 v[92:95], v[132:135], v[116:119], v[92:95]
    v_mfma_f32_16x16x32_bf16 v[76:79], v[132:135], v[112:115], v[76:79]
    s_add_u32 m0, s47, 0
    s_mul_i32 s44, s45, 10
    buffer_load_dwordx4 v187, s[28:31], s44 offen lds
    v_mfma_f32_16x16x32_bf16 v[60:63], v[132:135], v[108:111], v[60:63]
    v_mfma_f32_16x16x32_bf16 v[44:47], v[132:135], v[104:107], v[44:47]
    v_mfma_f32_16x16x32_bf16 v[28:31], v[132:135], v[100:103], v[28:31]
    v_mfma_f32_16x16x32_bf16 v[12:15], v[132:135], v[96:99], v[12:15]
    s_waitcnt vmcnt(9) lgkmcnt(0)
    s_barrier
    v_mfma_f32_16x16x32_bf16 v[0:3], v[160:163], v[136:139], v[0:3]
    ds_read_b64_tr_b16 v[120:121], v246 offset:32768
    v_mfma_f32_16x16x32_bf16 v[16:19], v[160:163], v[140:143], v[16:19]
    ds_read_b128 v[96:99], v245 offset:0
    v_mfma_f32_16x16x32_bf16 v[32:35], v[160:163], v[144:147], v[32:35]
    s_add_u32 m0, s48, 0
    s_mul_i32 s44, s45, 10
    buffer_load_dwordx4 v188, s[28:31], s44 offen lds
    v_mfma_f32_16x16x32_bf16 v[48:51], v[160:163], v[148:151], v[48:51]
    ds_read_b64_tr_b16 v[122:123], v246 offset:34816
    v_mfma_f32_16x16x32_bf16 v[64:67], v[160:163], v[152:155], v[64:67]
    ds_read_b128 v[100:103], v245 offset:2048
    v_mfma_f32_16x16x32_bf16 v[80:83], v[160:163], v[156:159], v[80:83]
    ds_read_b64_tr_b16 v[124:125], v247 offset:32768
    v_mfma_f32_16x16x32_bf16 v[84:87], v[164:167], v[156:159], v[84:87]
    ds_read_b128 v[104:107], v245 offset:4096
    v_mfma_f32_16x16x32_bf16 v[68:71], v[164:167], v[152:155], v[68:71]
    ds_read_b64_tr_b16 v[126:127], v247 offset:34816
    v_mfma_f32_16x16x32_bf16 v[52:55], v[164:167], v[148:151], v[52:55]
    s_add_u32 m0, s49, 49152
    s_movk_i32 s46, 640
    s_mov_b64 exec, s[56:57]
    buffer_load_dwordx4 v184, s[24:27], s46 offen lds
    s_mov_b64 exec, -1
    v_mfma_f32_16x16x32_bf16 v[36:39], v[164:167], v[144:147], v[36:39]
    ds_read_b64_tr_b16 v[128:129], v246 offset:40960
    v_mfma_f32_16x16x32_bf16 v[20:23], v[164:167], v[140:143], v[20:23]
    ds_read_b128 v[108:111], v245 offset:6144
    v_mfma_f32_16x16x32_bf16 v[4:7], v[164:167], v[136:139], v[4:7]
    ds_read_b64_tr_b16 v[130:131], v246 offset:43008
    v_mfma_f32_16x16x32_bf16 v[8:11], v[168:171], v[136:139], v[8:11]
    ds_read_b128 v[112:115], v245 offset:8192
    v_mfma_f32_16x16x32_bf16 v[24:27], v[168:171], v[140:143], v[24:27]
    s_add_u32 m0, s49, 57344
    s_movk_i32 s46, 640
    buffer_load_dwordx4 v185, s[24:27], s46 offen lds
    v_mfma_f32_16x16x32_bf16 v[40:43], v[168:171], v[144:147], v[40:43]
    ds_read_b64_tr_b16 v[132:133], v247 offset:40960
    v_mfma_f32_16x16x32_bf16 v[56:59], v[168:171], v[148:151], v[56:59]
    ds_read_b128 v[116:119], v245 offset:10240
    v_mfma_f32_16x16x32_bf16 v[72:75], v[168:171], v[152:155], v[72:75]
    ds_read_b64_tr_b16 v[134:135], v247 offset:43008
    v_mfma_f32_16x16x32_bf16 v[88:91], v[168:171], v[156:159], v[88:91]
    v_mfma_f32_16x16x32_bf16 v[92:95], v[172:175], v[156:159], v[92:95]
    v_mfma_f32_16x16x32_bf16 v[76:79], v[172:175], v[152:155], v[76:79]
    s_add_u32 m0, s49, 65536
    s_movk_i32 s46, 640
    buffer_load_dwordx4 v186, s[24:27], s46 offen lds
    v_mfma_f32_16x16x32_bf16 v[60:63], v[172:175], v[148:151], v[60:63]
    v_mfma_f32_16x16x32_bf16 v[44:47], v[172:175], v[144:147], v[44:47]
    v_mfma_f32_16x16x32_bf16 v[28:31], v[172:175], v[140:143], v[28:31]
    v_mfma_f32_16x16x32_bf16 v[12:15], v[172:175], v[136:139], v[12:15]
    s_waitcnt vmcnt(7) lgkmcnt(0)
    s_barrier
    v_mfma_f32_16x16x32_bf16 v[0:3], v[120:123], v[96:99], v[0:3]
    v_add_u32 v246, 49152, v246
    v_add_u32 v247, 49152, v247
    ds_read_b64_tr_b16 v[160:161], v246 offset:0
    v_mfma_f32_16x16x32_bf16 v[16:19], v[120:123], v[100:103], v[16:19]
    ds_read_b128 v[136:139], v244 offset:24576
    v_mfma_f32_16x16x32_bf16 v[32:35], v[120:123], v[104:107], v[32:35]
    s_add_u32 m0, s47, 16384
    s_mul_i32 s44, s45, 11
    buffer_load_dwordx4 v187, s[28:31], s44 offen lds
    v_mfma_f32_16x16x32_bf16 v[48:51], v[120:123], v[108:111], v[48:51]
    ds_read_b64_tr_b16 v[162:163], v246 offset:2048
    v_mfma_f32_16x16x32_bf16 v[64:67], v[120:123], v[112:115], v[64:67]
    ds_read_b128 v[140:143], v244 offset:26624
    v_mfma_f32_16x16x32_bf16 v[80:83], v[120:123], v[116:119], v[80:83]
    ds_read_b64_tr_b16 v[164:165], v247 offset:0
    v_mfma_f32_16x16x32_bf16 v[84:87], v[124:127], v[116:119], v[84:87]
    ds_read_b128 v[144:147], v244 offset:28672
    v_mfma_f32_16x16x32_bf16 v[68:71], v[124:127], v[112:115], v[68:71]
    ds_read_b64_tr_b16 v[166:167], v247 offset:2048
    v_mfma_f32_16x16x32_bf16 v[52:55], v[124:127], v[108:111], v[52:55]
    s_add_u32 m0, s48, 16384
    s_mul_i32 s44, s45, 11
    buffer_load_dwordx4 v188, s[28:31], s44 offen lds
    v_mfma_f32_16x16x32_bf16 v[36:39], v[124:127], v[104:107], v[36:39]
    ds_read_b64_tr_b16 v[168:169], v246 offset:8192
    v_mfma_f32_16x16x32_bf16 v[20:23], v[124:127], v[100:103], v[20:23]
    ds_read_b128 v[148:151], v244 offset:30720
    v_mfma_f32_16x16x32_bf16 v[4:7], v[124:127], v[96:99], v[4:7]
    ds_read_b64_tr_b16 v[170:171], v246 offset:10240
    v_mfma_f32_16x16x32_bf16 v[8:11], v[128:131], v[96:99], v[8:11]
    ds_read_b128 v[152:155], v244 offset:32768
    v_mfma_f32_16x16x32_bf16 v[24:27], v[128:131], v[100:103], v[24:27]
    s_add_u32 m0, s47, 32768
    s_mul_i32 s44, s45, 12
    buffer_load_dwordx4 v187, s[28:31], s44 offen lds
    v_mfma_f32_16x16x32_bf16 v[40:43], v[128:131], v[104:107], v[40:43]
    ds_read_b64_tr_b16 v[172:173], v247 offset:8192
    v_mfma_f32_16x16x32_bf16 v[56:59], v[128:131], v[108:111], v[56:59]
    ds_read_b128 v[156:159], v244 offset:34816
    v_mfma_f32_16x16x32_bf16 v[72:75], v[128:131], v[112:115], v[72:75]
    ds_read_b64_tr_b16 v[174:175], v247 offset:10240
    v_mfma_f32_16x16x32_bf16 v[88:91], v[128:131], v[116:119], v[88:91]
    v_mfma_f32_16x16x32_bf16 v[92:95], v[132:135], v[116:119], v[92:95]
    v_mfma_f32_16x16x32_bf16 v[76:79], v[132:135], v[112:115], v[76:79]
    s_add_u32 m0, s48, 32768
    s_mul_i32 s44, s45, 12
    buffer_load_dwordx4 v188, s[28:31], s44 offen lds
    v_mfma_f32_16x16x32_bf16 v[60:63], v[132:135], v[108:111], v[60:63]
    v_mfma_f32_16x16x32_bf16 v[44:47], v[132:135], v[104:107], v[44:47]
    v_mfma_f32_16x16x32_bf16 v[28:31], v[132:135], v[100:103], v[28:31]
    v_mfma_f32_16x16x32_bf16 v[12:15], v[132:135], v[96:99], v[12:15]
    s_waitcnt vmcnt(9) lgkmcnt(0)
    s_barrier
    v_mfma_f32_16x16x32_bf16 v[0:3], v[160:163], v[136:139], v[0:3]
    ds_read_b64_tr_b16 v[120:121], v246 offset:16384
    v_mfma_f32_16x16x32_bf16 v[16:19], v[160:163], v[140:143], v[16:19]
    ds_read_b128 v[96:99], v245 offset:24576
    v_mfma_f32_16x16x32_bf16 v[32:35], v[160:163], v[144:147], v[32:35]
    s_add_u32 m0, s49, 0
    s_movk_i32 s46, 768
    s_mov_b64 exec, s[56:57]
    buffer_load_dwordx4 v184, s[24:27], s46 offen lds
    s_mov_b64 exec, -1
    v_mfma_f32_16x16x32_bf16 v[48:51], v[160:163], v[148:151], v[48:51]
    ds_read_b64_tr_b16 v[122:123], v246 offset:18432
    v_mfma_f32_16x16x32_bf16 v[64:67], v[160:163], v[152:155], v[64:67]
    ds_read_b128 v[100:103], v245 offset:26624
    v_mfma_f32_16x16x32_bf16 v[80:83], v[160:163], v[156:159], v[80:83]
    ds_read_b64_tr_b16 v[124:125], v247 offset:16384
    v_mfma_f32_16x16x32_bf16 v[84:87], v[164:167], v[156:159], v[84:87]
    ds_read_b128 v[104:107], v245 offset:28672
    v_mfma_f32_16x16x32_bf16 v[68:71], v[164:167], v[152:155], v[68:71]
    ds_read_b64_tr_b16 v[126:127], v247 offset:18432
    v_mfma_f32_16x16x32_bf16 v[52:55], v[164:167], v[148:151], v[52:55]
    s_add_u32 m0, s49, 8192
    s_movk_i32 s46, 768
    buffer_load_dwordx4 v185, s[24:27], s46 offen lds
    v_mfma_f32_16x16x32_bf16 v[36:39], v[164:167], v[144:147], v[36:39]
    ds_read_b64_tr_b16 v[128:129], v246 offset:24576
    v_mfma_f32_16x16x32_bf16 v[20:23], v[164:167], v[140:143], v[20:23]
    ds_read_b128 v[108:111], v245 offset:30720
    v_mfma_f32_16x16x32_bf16 v[4:7], v[164:167], v[136:139], v[4:7]
    ds_read_b64_tr_b16 v[130:131], v246 offset:26624
    v_mfma_f32_16x16x32_bf16 v[8:11], v[168:171], v[136:139], v[8:11]
    ds_read_b128 v[112:115], v245 offset:32768
    v_mfma_f32_16x16x32_bf16 v[24:27], v[168:171], v[140:143], v[24:27]
    s_add_u32 m0, s49, 16384
    s_movk_i32 s46, 768
    buffer_load_dwordx4 v186, s[24:27], s46 offen lds
    v_mfma_f32_16x16x32_bf16 v[40:43], v[168:171], v[144:147], v[40:43]
    ds_read_b64_tr_b16 v[132:133], v247 offset:24576
    v_mfma_f32_16x16x32_bf16 v[56:59], v[168:171], v[148:151], v[56:59]
    ds_read_b128 v[116:119], v245 offset:34816
    v_mfma_f32_16x16x32_bf16 v[72:75], v[168:171], v[152:155], v[72:75]
    ds_read_b64_tr_b16 v[134:135], v247 offset:26624
    v_mfma_f32_16x16x32_bf16 v[88:91], v[168:171], v[156:159], v[88:91]
    v_mfma_f32_16x16x32_bf16 v[92:95], v[172:175], v[156:159], v[92:95]
    v_mfma_f32_16x16x32_bf16 v[76:79], v[172:175], v[152:155], v[76:79]
    s_add_u32 m0, s47, 49152
    s_mul_i32 s44, s45, 13
    buffer_load_dwordx4 v187, s[28:31], s44 offen lds
    v_mfma_f32_16x16x32_bf16 v[60:63], v[172:175], v[148:151], v[60:63]
    v_mfma_f32_16x16x32_bf16 v[44:47], v[172:175], v[144:147], v[44:47]
    v_mfma_f32_16x16x32_bf16 v[28:31], v[172:175], v[140:143], v[28:31]
    s_and_b32 s68, s40, 3
    s_add_u32 s46, s68, 7
    s_mul_i32 s46, s46, 221184
    s_cmp_lt_u32 s68, 2
    s_cselect_b32 s46, s46, 2211840
    buffer_load_dword v191, v189, s[28:31], s46 offen
    v_mfma_f32_16x16x32_bf16 v[12:15], v[172:175], v[136:139], v[12:15]
    s_waitcnt vmcnt(9) lgkmcnt(0)
    s_barrier
    v_mfma_f32_16x16x32_bf16 v[0:3], v[120:123], v[96:99], v[0:3]
    v_subrev_u32 v246, 49152, v246
    v_subrev_u32 v247, 49152, v247
    ds_read_b64_tr_b16 v[160:161], v246 offset:0
    v_mfma_f32_16x16x32_bf16 v[16:19], v[120:123], v[100:103], v[16:19]
    ds_read_b128 v[136:139], v244 offset:49152
    v_mfma_f32_16x16x32_bf16 v[32:35], v[120:123], v[104:107], v[32:35]
    s_add_u32 m0, s48, 49152
    s_mul_i32 s44, s45, 13
    buffer_load_dwordx4 v188, s[28:31], s44 offen lds
    v_mfma_f32_16x16x32_bf16 v[48:51], v[120:123], v[108:111], v[48:51]
    ds_read_b64_tr_b16 v[162:163], v246 offset:2048
    v_mfma_f32_16x16x32_bf16 v[64:67], v[120:123], v[112:115], v[64:67]
    ds_read_b128 v[140:143], v244 offset:51200
    v_mfma_f32_16x16x32_bf16 v[80:83], v[120:123], v[116:119], v[80:83]
    ds_read_b64_tr_b16 v[164:165], v247 offset:0
    v_mfma_f32_16x16x32_bf16 v[84:87], v[124:127], v[116:119], v[84:87]
    ds_read_b128 v[144:147], v244 offset:53248
    v_mfma_f32_16x16x32_bf16 v[68:71], v[124:127], v[112:115], v[68:71]
    ds_read_b64_tr_b16 v[166:167], v247 offset:2048
    v_mfma_f32_16x16x32_bf16 v[52:55], v[124:127], v[108:111], v[52:55]
    s_add_u32 m0, s47, 65536
    s_mul_i32 s44, s45, 14
    buffer_load_dwordx4 v187, s[28:31], s44 offen lds
    v_mfma_f32_16x16x32_bf16 v[36:39], v[124:127], v[104:107], v[36:39]
    ds_read_b64_tr_b16 v[168:169], v246 offset:8192
    v_mfma_f32_16x16x32_bf16 v[20:23], v[124:127], v[100:103], v[20:23]
    ds_read_b128 v[148:151], v244 offset:55296
    v_mfma_f32_16x16x32_bf16 v[4:7], v[124:127], v[96:99], v[4:7]
    ds_read_b64_tr_b16 v[170:171], v246 offset:10240
    v_mfma_f32_16x16x32_bf16 v[8:11], v[128:131], v[96:99], v[8:11]
    ds_read_b128 v[152:155], v244 offset:57344
    v_mfma_f32_16x16x32_bf16 v[24:27], v[128:131], v[100:103], v[24:27]
    s_add_u32 m0, s48, 65536
    s_mul_i32 s44, s45, 14
    buffer_load_dwordx4 v188, s[28:31], s44 offen lds
    v_mfma_f32_16x16x32_bf16 v[40:43], v[128:131], v[104:107], v[40:43]
    ds_read_b64_tr_b16 v[172:173], v247 offset:8192
    v_mfma_f32_16x16x32_bf16 v[56:59], v[128:131], v[108:111], v[56:59]
    ds_read_b128 v[156:159], v244 offset:59392
    v_mfma_f32_16x16x32_bf16 v[72:75], v[128:131], v[112:115], v[72:75]
    ds_read_b64_tr_b16 v[174:175], v247 offset:10240
    v_mfma_f32_16x16x32_bf16 v[88:91], v[128:131], v[116:119], v[88:91]
    v_mfma_f32_16x16x32_bf16 v[92:95], v[132:135], v[116:119], v[92:95]
    v_mfma_f32_16x16x32_bf16 v[76:79], v[132:135], v[112:115], v[76:79]
    s_add_u32 m0, s49, 24576
    s_movk_i32 s46, 896
    s_mov_b64 exec, s[56:57]
    buffer_load_dwordx4 v184, s[24:27], s46 offen lds
    s_mov_b64 exec, -1
    v_mfma_f32_16x16x32_bf16 v[60:63], v[132:135], v[108:111], v[60:63]
    v_mfma_f32_16x16x32_bf16 v[44:47], v[132:135], v[104:107], v[44:47]
    v_mfma_f32_16x16x32_bf16 v[28:31], v[132:135], v[100:103], v[28:31]
    v_mfma_f32_16x16x32_bf16 v[12:15], v[132:135], v[96:99], v[12:15]
    s_waitcnt vmcnt(11) lgkmcnt(0)
    s_barrier
    v_mfma_f32_16x16x32_bf16 v[0:3], v[160:163], v[136:139], v[0:3]
    ds_read_b64_tr_b16 v[120:121], v246 offset:16384
    v_mfma_f32_16x16x32_bf16 v[16:19], v[160:163], v[140:143], v[16:19]
    ds_read_b128 v[96:99], v245 offset:49152
    v_mfma_f32_16x16x32_bf16 v[32:35], v[160:163], v[144:147], v[32:35]
    s_add_u32 m0, s49, 32768
    s_movk_i32 s46, 896
    buffer_load_dwordx4 v185, s[24:27], s46 offen lds
    v_mfma_f32_16x16x32_bf16 v[48:51], v[160:163], v[148:151], v[48:51]
    ds_read_b64_tr_b16 v[122:123], v246 offset:18432
    v_mfma_f32_16x16x32_bf16 v[64:67], v[160:163], v[152:155], v[64:67]
    ds_read_b128 v[100:103], v245 offset:51200
    v_mfma_f32_16x16x32_bf16 v[80:83], v[160:163], v[156:159], v[80:83]
    ds_read_b64_tr_b16 v[124:125], v247 offset:16384
    v_mfma_f32_16x16x32_bf16 v[84:87], v[164:167], v[156:159], v[84:87]
    ds_read_b128 v[104:107], v245 offset:53248
    v_mfma_f32_16x16x32_bf16 v[68:71], v[164:167], v[152:155], v[68:71]
    ds_read_b64_tr_b16 v[126:127], v247 offset:18432
    v_mfma_f32_16x16x32_bf16 v[52:55], v[164:167], v[148:151], v[52:55]
    s_add_u32 m0, s49, 40960
    s_movk_i32 s46, 896
    buffer_load_dwordx4 v186, s[24:27], s46 offen lds
    v_mfma_f32_16x16x32_bf16 v[36:39], v[164:167], v[144:147], v[36:39]
    ds_read_b64_tr_b16 v[128:129], v246 offset:24576
    v_mfma_f32_16x16x32_bf16 v[20:23], v[164:167], v[140:143], v[20:23]
    ds_read_b128 v[108:111], v245 offset:55296
    v_mfma_f32_16x16x32_bf16 v[4:7], v[164:167], v[136:139], v[4:7]
    s_cmp_eq_u32 s40, 0
    s_cbranch_scc0 SK_9
    v_and_b32 v253, 0xf0, v254
    buffer_load_dword v252, v253, s[64:67], 0 offen sc1
SK_9:
    v_mfma_f32_16x16x32_bf16 v[8:11], v[168:171], v[136:139], v[8:11]
    ds_read_b64_tr_b16 v[130:131], v246 offset:26624
    v_mfma_f32_16x16x32_bf16 v[24:27], v[168:171], v[140:143], v[24:27]
    ds_read_b128 v[112:115], v245 offset:57344
    v_mfma_f32_16x16x32_bf16 v[40:43], v[168:171], v[144:147], v[40:43]
    s_add_u32 m0, s47, 0
    s_mul_i32 s44, s45, 15
    buffer_load_dwordx4 v187, s[28:31], s44 offen lds
    v_mfma_f32_16x16x32_bf16 v[56:59], v[168:171], v[148:151], v[56:59]
    ds_read_b64_tr_b16 v[132:133], v247 offset:24576
    v_mfma_f32_16x16x32_bf16 v[72:75], v[168:171], v[152:155], v[72:75]
    ds_read_b128 v[116:119], v245 offset:59392
    v_mfma_f32_16x16x32_bf16 v[88:91], v[168:171], v[156:159], v[88:91]
    ds_read_b64_tr_b16 v[134:135], v247 offset:26624
    v_mfma_f32_16x16x32_bf16 v[92:95], v[172:175], v[156:159], v[92:95]
    v_mfma_f32_16x16x32_bf16 v[76:79], v[172:175], v[152:155], v[76:79]
    v_mfma_f32_16x16x32_bf16 v[60:63], v[172:175], v[148:151], v[60:63]
    s_add_u32 m0, s48, 0
    s_mul_i32 s44, s45, 15
    buffer_load_dwordx4 v188, s[28:31], s44 offen lds
    v_mfma_f32_16x16x32_bf16 v[44:47], v[172:175], v[144:147], v[44:47]
    v_mfma_f32_16x16x32_bf16 v[28:31], v[172:175], v[140:143], v[28:31]
    v_mfma_f32_16x16x32_bf16 v[12:15], v[172:175], v[136:139], v[12:15]
    s_waitcnt vmcnt(10) lgkmcnt(0)
    s_cmp_lg_u32 s40, 0
    s_cbranch_scc1 CR_g_OK
    s_waitcnt vmcnt(2)
    s_mov_b32 s3, 0
CR_g_CHK:
    v_cmp_gt_u32 vcc, 16, v252
    s_nop 0
    s_cmp_eq_u64 vcc, 0
    s_cbranch_scc1 CR_g_OK
    s_add_u32 s3, s3, 1
    s_cmp_gt_u32 s3, 2097152
    s_cbranch_scc1 CR_g_OK
    s_sleep 24
    s_cmp_ge_u32 s42, 14
    s_cbranch_scc0 SK_13
    s_sleep 100
SK_13:
    buffer_load_dword v252, v253, s[64:67], 0 offen sc1
    s_waitcnt vmcnt(0)
    s_branch CR_g_CHK
CR_g_OK:
    s_barrier
    v_mfma_f32_16x16x32_bf16 v[0:3], v[120:123], v[96:99], v[0:3]
    ds_read_b64_tr_b16 v[160:161], v246 offset:32768
    ds_read_b128 v[136:139], v244 offset:0
    v_mfma_f32_16x16x32_bf16 v[16:19], v[120:123], v[100:103], v[16:19]
    s_add_u32 m0, s47, 16384
    s_mul_i32 s44, s45, 16
    buffer_load_dwordx4 v187, s[28:31], s44 offen lds
    v_mfma_f32_16x16x32_bf16 v[32:35], v[120:123], v[104:107], v[32:35]
    ds_read_b64_tr_b16 v[162:163], v246 offset:34816
    v_mfma_f32_16x16x32_bf16 v[48:51], v[120:123], v[108:111], v[48:51]
    ds_read_b128 v[140:143], v244 offset:2048
    v_mfma_f32_16x16x32_bf16 v[64:67], v[120:123], v[112:115], v[64:67]
    ds_read_b64_tr_b16 v[164:165], v247 offset:32768
    v_mfma_f32_16x16x32_bf16 v[80:83], v[120:123], v[116:119], v[80:83]
    s_add_u32 m0, s48, 16384
    s_mul_i32 s44, s45, 16
    buffer_load_dwordx4 v188, s[28:31], s44 offen lds
    v_mfma_f32_16x16x32_bf16 v[84:87], v[124:127], v[116:119], v[84:87]
    ds_read_b128 v[144:147], v244 offset:4096
    v_mfma_f32_16x16x32_bf16 v[68:71], v[124:127], v[112:115], v[68:71]
    ds_read_b64_tr_b16 v[166:167], v247 offset:34816
    v_mfma_f32_16x16x32_bf16 v[52:55], v[124:127], v[108:111], v[52:55]
    ds_read_b64_tr_b16 v[168:169], v246 offset:40960
    v_mfma_f32_16x16x32_bf16 v[36:39], v[124:127], v[104:107], v[36:39]
    ds_read_b128 v[148:151], v244 offset:6144
    v_mfma_f32_16x16x32_bf16 v[20:23], v[124:127], v[100:103], v[20:23]
    s_add_u32 m0, s49, 49152
    s_movk_i32 s46, 1024
    s_mov_b64 exec, s[56:57]
    buffer_load_dwordx4 v184, s[24:27], s46 offen lds
    s_mov_b64 exec, -1
    v_mfma_f32_16x16x32_bf16 v[4:7], v[124:127], v[96:99], v[4:7]
    ds_read_b64_tr_b16 v[170:171], v246 offset:43008
    v_mfma_f32_16x16x32_bf16 v[8:11], v[128:131], v[96:99], v[8:11]
    ds_read_b128 v[152:155], v244 offset:8192
    v_mfma_f32_16x16x32_bf16 v[24:27], v[128:131], v[100:103], v[24:27]
    ds_read_b64_tr_b16 v[172:173], v247 offset:40960
    v_mfma_f32_16x16x32_bf16 v[40:43], v[128:131], v[104:107], v[40:43]
    ds_read_b128 v[156:159], v244 offset:10240
    v_mfma_f32_16x16x32_bf16 v[56:59], v[128:131], v[108:111], v[56:59]
    s_add_u32 m0, s49, 57344
    s_movk_i32 s46, 1024
    buffer_load_dwordx4 v185, s[24:27], s46 offen lds
    v_mfma_f32_16x16x32_bf16 v[72:75], v[128:131], v[112:115], v[72:75]
    ds_read_b64_tr_b16 v[174:175], v247 offset:43008
    v_mfma_f32_16x16x32_bf16 v[88:91], v[128:131], v[116:119], v[88:91]
    v_mfma_f32_16x16x32_bf16 v[92:95], v[132:135], v[116:119], v[92:95]
    v_mfma_f32_16x16x32_bf16 v[76:79], v[132:135], v[112:115], v[76:79]
    s_add_u32 m0, s49, 65536
    s_movk_i32 s46, 1024
    buffer_load_dwordx4 v186, s[24:27], s46 offen lds
    v_mfma_f32_16x16x32_bf16 v[60:63], v[132:135], v[108:111], v[60:63]
    v_mfma_f32_16x16x32_bf16 v[44:47], v[132:135], v[104:107], v[44:47]
    v_mfma_f32_16x16x32_bf16 v[28:31], v[132:135], v[100:103], v[28:31]
    s_and_b32 s68, s40, 3
    s_add_u32 s46, s68, 9
    s_mul_i32 s46, s46, 221184
    s_cmp_lt_u32 s68, 1
    s_cselect_b32 s46, s46, 2211840
    buffer_load_dword v191, v189, s[28:31], s46 offen
    v_mfma_f32_16x16x32_bf16 v[12:15], v[132:135], v[96:99], v[12:15]
    s_waitcnt vmcnt(13) lgkmcnt(0)
    s_barrier
    v_mfma_f32_16x16x32_bf16 v[0:3], v[160:163], v[136:139], v[0:3]
    v_add_u32 v246, 49152, v246
    v_add_u32 v247, 49152, v247
    ds_read_b64_tr_b16 v[120:121], v246 offset:0
    v_mfma_f32_16x16x32_bf16 v[16:19], v[160:163], v[140:143], v[16:19]
    ds_read_b128 v[96:99], v245 offset:0
    v_mfma_f32_16x16x32_bf16 v[32:35], v[160:163], v[144:147], v[32:35]
    s_add_u32 m0, s47, 32768
    s_mul_i32 s44, s45, 17
    buffer_load_dwordx4 v187, s[28:31], s44 offen lds
    v_mfma_f32_16x16x32_bf16 v[48:51], v[160:163], v[148:151], v[48:51]
    ds_read_b64_tr_b16 v[122:123], v246 offset:2048
    v_mfma_f32_16x16x32_bf16 v[64:67], v[160:163], v[152:155], v[64:67]
    ds_read_b128 v[100:103], v245 offset:2048
    v_mfma_f32_16x16x32_bf16 v[80:83], v[160:163], v[156:159], v[80:83]
    ds_read_b64_tr_b16 v[124:125], v247 offset:0
    v_mfma_f32_16x16x32_bf16 v[84:87], v[164:167], v[156:159], v[84:87]
    s_add_u32 m0, s48, 32768
    s_mul_i32 s44, s45, 17
    buffer_load_dwordx4 v188, s[28:31], s44 offen lds
    v_mfma_f32_16x16x32_bf16 v[68:71], v[164:167], v[152:155], v[68:71]
    ds_read_b128 v[104:107], v245 offset:4096
    v_mfma_f32_16x16x32_bf16 v[52:55], v[164:167], v[148:151], v[52:55]
    ds_read_b64_tr_b16 v[126:127], v247 offset:2048
    v_mfma_f32_16x16x32_bf16 v[36:39], v[164:167], v[144:147], v[36:39]
    ds_read_b64_tr_b16 v[128:129], v246 offset:8192
    v_mfma_f32_16x16x32_bf16 v[20:23], v[164:167], v[140:143], v[20:23]
    ds_read_b128 v[108:111], v245 offset:6144
    v_mfma_f32_16x16x32_bf16 v[4:7], v[164:167], v[136:139], v[4:7]
    s_add_u32 s88, s92, 1
    s_add_u32 s88, s88, s94
    s_mul_i32 s88, s88, 5120
    s_add_u32 s89, s88, 4096
    buffer_load_dwordx4 v[204:207], v254, s[52:55], s88 offen offset:0 sc1
    v_mfma_f32_16x16x32_bf16 v[8:11], v[168:171], v[136:139], v[8:11]
    ds_read_b64_tr_b16 v[130:131], v246 offset:10240
    v_mfma_f32_16x16x32_bf16 v[24:27], v[168:171], v[140:143], v[24:27]
    ds_read_b128 v[112:115], v245 offset:8192
    v_mfma_f32_16x16x32_bf16 v[40:43], v[168:171], v[144:147], v[40:43]
    ds_read_b64_tr_b16 v[132:133], v247 offset:8192
    v_mfma_f32_16x16x32_bf16 v[56:59], v[168:171], v[148:151], v[56:59]
    ds_read_b128 v[116:119], v245 offset:10240
    v_mfma_f32_16x16x32_bf16 v[72:75], v[168:171], v[152:155], v[72:75]
    buffer_load_dwordx4 v[208:211], v254, s[52:55], s88 offen offset:1024 sc1
    v_mfma_f32_16x16x32_bf16 v[88:91], v[168:171], v[156:159], v[88:91]
    ds_read_b64_tr_b16 v[134:135], v247 offset:10240
    v_mfma_f32_16x16x32_bf16 v[92:95], v[172:175], v[156:159], v[92:95]
    v_mfma_f32_16x16x32_bf16 v[76:79], v[172:175], v[152:155], v[76:79]
    v_mfma_f32_16x16x32_bf16 v[60:63], v[172:175], v[148:151], v[60:63]
    buffer_load_dwordx4 v[212:215], v254, s[52:55], s88 offen offset:2048 sc1
    v_mfma_f32_16x16x32_bf16 v[44:47], v[172:175], v[144:147], v[44:47]
    v_mfma_f32_16x16x32_bf16 v[28:31], v[172:175], v[140:143], v[28:31]
    v_mfma_f32_16x16x32_bf16 v[12:15], v[172:175], v[136:139], v[12:15]
    s_waitcnt vmcnt(13) lgkmcnt(0)
    s_barrier
    v_mfma_f32_16x16x32_bf16 v[0:3], v[120:123], v[96:99], v[0:3]
    ds_read_b64_tr_b16 v[160:161], v246 offset:16384
    v_mfma_f32_16x16x32_bf16 v[16:19], v[120:123], v[100:103], v[16:19]
    ds_read_b128 v[136:139], v244 offset:24576
    v_mfma_f32_16x16x32_bf16 v[32:35], v[120:123], v[104:107], v[32:35]
    s_add_u32 m0, s47, 49152
    s_mul_i32 s44, s45, 18
    buffer_load_dwordx4 v187, s[28:31], s44 offen lds
    v_mfma_f32_16x16x32_bf16 v[48:51], v[120:123], v[108:111], v[48:51]
    ds_read_b64_tr_b16 v[162:163], v246 offset:18432
    v_mfma_f32_16x16x32_bf16 v[64:67], v[120:123], v[112:115], v[64:67]
    ds_read_b128 v[140:143], v244 offset:26624
    v_mfma_f32_16x16x32_bf16 v[80:83], v[120:123], v[116:119], v[80:83]
    ds_read_b64_tr_b16 v[164:165], v247 offset:16384
    v_mfma_f32_16x16x32_bf16 v[84:87], v[124:127], v[116:119], v[84:87]
    s_add_u32 m0, s48, 49152
    s_mul_i32 s44, s45, 18
    buffer_load_dwordx4 v188, s[28:31], s44 offen lds
    v_mfma_f32_16x16x32_bf16 v[68:71], v[124:127], v[112:115], v[68:71]
    ds_read_b128 v[144:147], v244 offset:28672
    v_mfma_f32_16x16x32_bf16 v[52:55], v[124:127], v[108:111], v[52:55]
    ds_read_b64_tr_b16 v[166:167], v247 offset:18432
    v_mfma_f32_16x16x32_bf16 v[36:39], v[124:127], v[104:107], v[36:39]
    ds_read_b64_tr_b16 v[168:169], v246 offset:24576
    v_mfma_f32_16x16x32_bf16 v[20:23], v[124:127], v[100:103], v[20:23]
    ds_read_b128 v[148:151], v244 offset:30720
    v_mfma_f32_16x16x32_bf16 v[4:7], v[124:127], v[96:99], v[4:7]
    s_add_u32 m0, s49, 0
    s_movk_i32 s46, 1152
    s_mov_b64 exec, s[56:57]
    buffer_load_dwordx4 v184, s[24:27], s46 offen lds
    s_mov_b64 exec, -1
    v_mfma_f32_16x16x32_bf16 v[8:11], v[128:131], v[96:99], v[8:11]
    ds_read_b64_tr_b16 v[170:171], v246 offset:26624
    v_mfma_f32_16x16x32_bf16 v[24:27], v[128:131], v[100:103], v[24:27]
    ds_read_b128 v[152:155], v244 offset:32768
    v_mfma_f32_16x16x32_bf16 v[40:43], v[128:131], v[104:107], v[40:43]
    ds_read_b64_tr_b16 v[172:173], v247 offset:24576
    v_mfma_f32_16x16x32_bf16 v[56:59], v[128:131], v[108:111], v[56:59]
    ds_read_b128 v[156:159], v244 offset:34816
    v_mfma_f32_16x16x32_bf16 v[72:75], v[128:131], v[112:115], v[72:75]
    s_add_u32 m0, s49, 8192
    s_movk_i32 s46, 1152
    buffer_load_dwordx4 v185, s[24:27], s46 offen lds
    v_mfma_f32_16x16x32_bf16 v[88:91], v[128:131], v[116:119], v[88:91]
    ds_read_b64_tr_b16 v[174:175], v247 offset:26624
    v_mfma_f32_16x16x32_bf16 v[92:95], v[132:135], v[116:119], v[92:95]
    v_mfma_f32_16x16x32_bf16 v[76:79], v[132:135], v[112:115], v[76:79]
    v_mfma_f32_16x16x32_bf16 v[60:63], v[132:135], v[108:111], v[60:63]
    s_add_u32 m0, s49, 16384
    s_movk_i32 s46, 1152
    buffer_load_dwordx4 v186, s[24:27], s46 offen lds
    v_mfma_f32_16x16x32_bf16 v[44:47], v[132:135], v[104:107], v[44:47]
    v_mfma_f32_16x16x32_bf16 v[28:31], v[132:135], v[100:103], v[28:31]
    v_mfma_f32_16x16x32_bf16 v[12:15], v[132:135], v[96:99], v[12:15]
    s_waitcnt vmcnt(16) lgkmcnt(0)
    s_barrier
    v_mfma_f32_16x16x32_bf16 v[0:3], v[160:163], v[136:139], v[0:3]
    v_subrev_u32 v246, 49152, v246
    v_subrev_u32 v247, 49152, v247
    ds_read_b64_tr_b16 v[120:121], v246 offset:0
    v_mfma_f32_16x16x32_bf16 v[16:19], v[160:163], v[140:143], v[16:19]
    ds_read_b128 v[96:99], v245 offset:24576
    v_mfma_f32_16x16x32_bf16 v[32:35], v[160:163], v[144:147], v[32:35]
    s_add_u32 m0, s47, 65536
    s_mul_i32 s44, s45, 19
    buffer_load_dwordx4 v187, s[28:31], s44 offen lds
    v_mfma_f32_16x16x32_bf16 v[48:51], v[160:163], v[148:151], v[48:51]
    ds_read_b64_tr_b16 v[122:123], v246 offset:2048
    v_mfma_f32_16x16x32_bf16 v[64:67], v[160:163], v[152:155], v[64:67]
    ds_read_b128 v[100:103], v245 offset:26624
    v_mfma_f32_16x16x32_bf16 v[80:83], v[160:163], v[156:159], v[80:83]
    ds_read_b64_tr_b16 v[124:125], v247 offset:0
    v_mfma_f32_16x16x32_bf16 v[84:87], v[164:167], v[156:159], v[84:87]
    s_add_u32 m0, s48, 65536
    s_mul_i32 s44, s45, 19
    buffer_load_dwordx4 v188, s[28:31], s44 offen lds
    v_mfma_f32_16x16x32_bf16 v[68:71], v[164:167], v[152:155], v[68:71]
    ds_read_b128 v[104:107], v245 offset:28672
    v_mfma_f32_16x16x32_bf16 v[52:55], v[164:167], v[148:151], v[52:55]
    ds_read_b64_tr_b16 v[126:127], v247 offset:2048
    v_mfma_f32_16x16x32_bf16 v[36:39], v[164:167], v[144:147], v[36:39]
    ds_read_b64_tr_b16 v[128:129], v246 offset:8192
    v_mfma_f32_16x16x32_bf16 v[20:23], v[164:167], v[140:143], v[20:23]
    ds_read_b128 v[108:111], v245 offset:30720
    v_mfma_f32_16x16x32_bf16 v[4:7], v[164:167], v[136:139], v[4:7]
    buffer_load_dwordx4 v[216:219], v254, s[52:55], s88 offen offset:3072 sc1
    v_mfma_f32_16x16x32_bf16 v[8:11], v[168:171], v[136:139], v[8:11]
    ds_read_b64_tr_b16 v[130:131], v246 offset:10240
    v_mfma_f32_16x16x32_bf16 v[24:27], v[168:171], v[140:143], v[24:27]
    ds_read_b128 v[112:115], v245 offset:32768
    v_mfma_f32_16x16x32_bf16 v[40:43], v[168:171], v[144:147], v[40:43]
    ds_read_b64_tr_b16 v[132:133], v247 offset:8192
    v_mfma_f32_16x16x32_bf16 v[56:59], v[168:171], v[148:151], v[56:59]
    ds_read_b128 v[116:119], v245 offset:34816
    v_mfma_f32_16x16x32_bf16 v[72:75], v[168:171], v[152:155], v[72:75]
    buffer_load_dwordx4 v[220:223], v254, s[52:55], s89 offen sc1
    v_mfma_f32_16x16x32_bf16 v[88:91], v[168:171], v[156:159], v[88:91]
    ds_read_b64_tr_b16 v[134:135], v247 offset:10240
    v_mfma_f32_16x16x32_bf16 v[92:95], v[172:175], v[156:159], v[92:95]
    v_mfma_f32_16x16x32_bf16 v[76:79], v[172:175], v[152:155], v[76:79]
    v_mfma_f32_16x16x32_bf16 v[60:63], v[172:175], v[148:151], v[60:63]
    s_add_u32 s88, s92, 2
    s_add_u32 s88, s88, s94
    s_mul_i32 s88, s88, 5120
    s_add_u32 s89, s88, 4096
    buffer_load_dwordx4 v[224:227], v254, s[52:55], s88 offen offset:0 sc1
    v_mfma_f32_16x16x32_bf16 v[44:47], v[172:175], v[144:147], v[44:47]
    v_mfma_f32_16x16x32_bf16 v[28:31], v[172:175], v[140:143], v[28:31]
    v_mfma_f32_16x16x32_bf16 v[12:15], v[172:175], v[136:139], v[12:15]
    s_waitcnt vmcnt(16) lgkmcnt(0)
    s_barrier
    v_mfma_f32_16x16x32_bf16 v[0:3], v[120:123], v[96:99], v[0:3]
    ds_read_b64_tr_b16 v[160:161], v246 offset:16384
    ds_read_b128 v[136:139], v244 offset:49152
    v_mfma_f32_16x16x32_bf16 v[16:19], v[120:123], v[100:103], v[16:19]
    s_add_u32 s44, s93, 7
    s_add_u32 s44, s44, s94
    s_mul_i32 s44, s44, 5120
    s_add_u32 m0, s49, 73728
    s_nop 0
    buffer_load_dwordx4 v254, s[52:55], s44 offen sc1 lds
    v_mfma_f32_16x16x32_bf16 v[32:35], v[120:123], v[104:107], v[32:35]
    ds_read_b64_tr_b16 v[162:163], v246 offset:18432
    v_mfma_f32_16x16x32_bf16 v[48:51], v[120:123], v[108:111], v[48:51]
    ds_read_b128 v[140:143], v244 offset:51200
    v_mfma_f32_16x16x32_bf16 v[64:67], v[120:123], v[112:115], v[64:67]
    ds_read_b64_tr_b16 v[164:165], v247 offset:16384
    v_mfma_f32_16x16x32_bf16 v[80:83], v[120:123], v[116:119], v[80:83]
    s_add_u32 s44, s44, 1024
    s_add_u32 m0, s49, 81920
    s_nop 0
    buffer_load_dwordx4 v254, s[52:55], s44 offen sc1 lds
    v_mfma_f32_16x16x32_bf16 v[84:87], v[124:127], v[116:119], v[84:87]
    ds_read_b128 v[144:147], v244 offset:53248
    v_mfma_f32_16x16x32_bf16 v[68:71], v[124:127], v[112:115], v[68:71]
    ds_read_b64_tr_b16 v[166:167], v247 offset:18432
    v_mfma_f32_16x16x32_bf16 v[52:55], v[124:127], v[108:111], v[52:55]
    ds_read_b64_tr_b16 v[168:169], v246 offset:24576
    v_mfma_f32_16x16x32_bf16 v[36:39], v[124:127], v[104:107], v[36:39]
    ds_read_b128 v[148:151], v244 offset:55296
    v_mfma_f32_16x16x32_bf16 v[20:23], v[124:127], v[100:103], v[20:23]
    s_add_u32 s45, s92, 5
    s_add_u32 s45, s45, s94
    s_mul_i32 s45, s45, 5120
    s_add_u32 m0, s49, 24576
    s_nop 0
    buffer_load_dwordx4 v254, s[52:55], s45 offen sc1 lds
    v_mfma_f32_16x16x32_bf16 v[4:7], v[124:127], v[96:99], v[4:7]
    s_sub_u32 s70, s40, 1
    s_cmp_lt_u32 s70, 3
    s_cbranch_scc0 SK_10
    s_mul_i32 s68, s41, 188
    s_sub_u32 s68, s68, 4
    s_lshl_b32 s68, s68, 4
    s_lshl_b32 s70, s70, 10
    s_add_u32 s68, s68, s70
    v_add_u32 v253, s68, v254
    s_add_u32 s70, s70, 157696
    v_add_u32 v250, s70, v254
    buffer_load_dwordx4 v[236:239], v253, s[32:35], 0 offen sc1
SK_10:
    v_mfma_f32_16x16x32_bf16 v[8:11], v[128:131], v[96:99], v[8:11]
    ds_read_b64_tr_b16 v[170:171], v246 offset:26624
    v_mfma_f32_16x16x32_bf16 v[24:27], v[128:131], v[100:103], v[24:27]
    ds_read_b128 v[152:155], v244 offset:57344
    v_mfma_f32_16x16x32_bf16 v[40:43], v[128:131], v[104:107], v[40:43]
    ds_read_b64_tr_b16 v[172:173], v247 offset:24576
    v_mfma_f32_16x16x32_bf16 v[56:59], v[128:131], v[108:111], v[56:59]
    ds_read_b128 v[156:159], v244 offset:59392
    v_mfma_f32_16x16x32_bf16 v[72:75], v[128:131], v[112:115], v[72:75]
    s_add_u32 s45, s45, 1024
    s_add_u32 m0, s49, 32768
    s_nop 0
    buffer_load_dwordx4 v254, s[52:55], s45 offen sc1 lds
    v_mfma_f32_16x16x32_bf16 v[88:91], v[128:131], v[116:119], v[88:91]
    ds_read_b64_tr_b16 v[174:175], v247 offset:26624
    v_mfma_f32_16x16x32_bf16 v[92:95], v[132:135], v[116:119], v[92:95]
    v_mfma_f32_16x16x32_bf16 v[76:79], v[132:135], v[112:115], v[76:79]
    v_mfma_f32_16x16x32_bf16 v[60:63], v[132:135], v[108:111], v[60:63]
    s_add_u32 s45, s45, 1024
    s_add_u32 m0, s49, 40960
    s_nop 0
    buffer_load_dwordx4 v254, s[52:55], s45 offen sc1 lds
    v_mfma_f32_16x16x32_bf16 v[44:47], v[132:135], v[104:107], v[44:47]
    v_mfma_f32_16x16x32_bf16 v[28:31], v[132:135], v[100:103], v[28:31]
    v_mfma_f32_16x16x32_bf16 v[12:15], v[132:135], v[96:99], v[12:15]
    s_waitcnt vmcnt(18) lgkmcnt(0)
    s_barrier
    v_mfma_f32_16x16x32_bf16 v[0:3], v[160:163], v[136:139], v[0:3]
    ds_read_b64_tr_b16 v[120:121], v246 offset:32768
    v_mfma_f32_16x16x32_bf16 v[16:19], v[160:163], v[140:143], v[16:19]
    ds_read_b128 v[96:99], v245 offset:49152
    v_mfma_f32_16x16x32_bf16 v[32:35], v[160:163], v[144:147], v[32:35]
    s_add_u32 s44, s44, 1024
    s_add_u32 m0, s49, 90112
    s_nop 0
    buffer_load_dwordx4 v254, s[52:55], s44 offen sc1 lds
    v_mfma_f32_16x16x32_bf16 v[48:51], v[160:163], v[148:151], v[48:51]
    ds_read_b64_tr_b16 v[122:123], v246 offset:34816
    v_mfma_f32_16x16x32_bf16 v[64:67], v[160:163], v[152:155], v[64:67]
    ds_read_b128 v[100:103], v245 offset:51200
    v_mfma_f32_16x16x32_bf16 v[80:83], v[160:163], v[156:159], v[80:83]
    ds_read_b64_tr_b16 v[124:125], v247 offset:32768
    v_mfma_f32_16x16x32_bf16 v[84:87], v[164:167], v[156:159], v[84:87]
    s_add_u32 s44, s44, 1024
    s_add_u32 m0, s49, 98304
    s_nop 0
    buffer_load_dwordx4 v254, s[52:55], s44 offen sc1 lds
    v_mfma_f32_16x16x32_bf16 v[68:71], v[164:167], v[152:155], v[68:71]
    ds_read_b128 v[104:107], v245 offset:53248
    v_mfma_f32_16x16x32_bf16 v[52:55], v[164:167], v[148:151], v[52:55]
    ds_read_b64_tr_b16 v[126:127], v247 offset:34816
    v_mfma_f32_16x16x32_bf16 v[36:39], v[164:167], v[144:147], v[36:39]
    ds_read_b64_tr_b16 v[128:129], v246 offset:40960
    v_mfma_f32_16x16x32_bf16 v[20:23], v[164:167], v[140:143], v[20:23]
    ds_read_b128 v[108:111], v245 offset:55296
    v_mfma_f32_16x16x32_bf16 v[4:7], v[164:167], v[136:139], v[4:7]
    buffer_load_dwordx4 v[228:231], v254, s[52:55], s88 offen offset:1024 sc1
    v_mfma_f32_16x16x32_bf16 v[8:11], v[168:171], v[136:139], v[8:11]
    ds_read_b64_tr_b16 v[130:131], v246 offset:43008
    v_mfma_f32_16x16x32_bf16 v[24:27], v[168:171], v[140:143], v[24:27]
    ds_read_b128 v[112:115], v245 offset:57344
    v_mfma_f32_16x16x32_bf16 v[40:43], v[168:171], v[144:147], v[40:43]
    ds_read_b64_tr_b16 v[132:133], v247 offset:40960
    v_mfma_f32_16x16x32_bf16 v[56:59], v[168:171], v[148:151], v[56:59]
    ds_read_b128 v[116:119], v245 offset:59392
    v_mfma_f32_16x16x32_bf16 v[72:75], v[168:171], v[152:155], v[72:75]
    buffer_load_dwordx4 v[232:235], v254, s[52:55], s88 offen offset:2048 sc1
    v_mfma_f32_16x16x32_bf16 v[88:91], v[168:171], v[156:159], v[88:91]
    ds_read_b64_tr_b16 v[134:135], v247 offset:43008
    v_mfma_f32_16x16x32_bf16 v[92:95], v[172:175], v[156:159], v[92:95]
    v_mfma_f32_16x16x32_bf16 v[76:79], v[172:175], v[152:155], v[76:79]
    v_mfma_f32_16x16x32_bf16 v[60:63], v[172:175], v[148:151], v[60:63]
    s_add_u32 s88, s92, 0
    s_add_u32 s88, s88, s94
    s_mul_i32 s88, s88, 5120
    s_add_u32 s89, s88, 4096
    buffer_load_dwordx4 v[184:187], v254, s[52:55], s88 offen offset:0 sc1
    v_mfma_f32_16x16x32_bf16 v[44:47], v[172:175], v[144:147], v[44:47]
    v_mfma_f32_16x16x32_bf16 v[28:31], v[172:175], v[140:143], v[28:31]
    v_mfma_f32_16x16x32_bf16 v[12:15], v[172:175], v[136:139], v[12:15]
    s_waitcnt vmcnt(15) lgkmcnt(0)
    s_barrier
    v_mfma_f32_16x16x32_bf16 v[0:3], v[120:123], v[96:99], v[0:3]
    v_add_u32 v246, 49152, v246
    v_add_u32 v247, 49152, v247
    ds_read_b64_tr_b16 v[160:161], v246 offset:0
    ds_read_b128 v[136:139], v244 offset:0
    v_mfma_f32_16x16x32_bf16 v[16:19], v[120:123], v[100:103], v[16:19]
    s_add_u32 s44, s44, 1024
    s_add_u32 m0, s49, 106496
    s_nop 0
    buffer_load_dwordx4 v254, s[52:55], s44 offen sc1 lds
    v_mfma_f32_16x16x32_bf16 v[32:35], v[120:123], v[104:107], v[32:35]
    ds_read_b64_tr_b16 v[162:163], v246 offset:2048
    v_mfma_f32_16x16x32_bf16 v[48:51], v[120:123], v[108:111], v[48:51]
    ds_read_b128 v[140:143], v244 offset:2048
    v_mfma_f32_16x16x32_bf16 v[64:67], v[120:123], v[112:115], v[64:67]
    ds_read_b64_tr_b16 v[164:165], v247 offset:0
    v_mfma_f32_16x16x32_bf16 v[80:83], v[120:123], v[116:119], v[80:83]
    s_add_u32 s44, s93, 8
    s_add_u32 s44, s44, s94
    s_mul_i32 s44, s44, 5120
    s_add_u32 m0, s49, 114688
    s_nop 0
    buffer_load_dwordx4 v254, s[52:55], s44 offen sc1 lds
    v_mfma_f32_16x16x32_bf16 v[84:87], v[124:127], v[116:119], v[84:87]
    ds_read_b128 v[144:147], v244 offset:4096
    v_mfma_f32_16x16x32_bf16 v[68:71], v[124:127], v[112:115], v[68:71]
    ds_read_b64_tr_b16 v[166:167], v247 offset:2048
    v_mfma_f32_16x16x32_bf16 v[52:55], v[124:127], v[108:111], v[52:55]
    ds_read_b64_tr_b16 v[168:169], v246 offset:8192
    v_mfma_f32_16x16x32_bf16 v[36:39], v[124:127], v[104:107], v[36:39]
    ds_read_b128 v[148:151], v244 offset:6144
    v_mfma_f32_16x16x32_bf16 v[20:23], v[124:127], v[100:103], v[20:23]
    s_add_u32 s45, s45, 1024
    s_add_u32 m0, s49, 49152
    s_nop 0
    buffer_load_dwordx4 v254, s[52:55], s45 offen sc1 lds
    v_mfma_f32_16x16x32_bf16 v[4:7], v[124:127], v[96:99], v[4:7]
    s_sub_u32 s70, s40, 1
    s_cmp_lt_u32 s70, 3
    s_cbranch_scc0 SK_11
    s_waitcnt vmcnt(10)
    v_mov_b32 v240, v236
    v_mov_b32 v241, v236
    v_mov_b32 v242, v238
    v_mov_b32 v243, v238
    v_mov_b32 v238, v237
    v_mov_b32 v236, v239
    v_mov_b32 v237, v239
    v_mov_b32 v239, v238
    ds_write_b128 v250, v[240:243]
    ds_write_b128 v250, v[236:239] offset:3072
SK_11:
    v_mfma_f32_16x16x32_bf16 v[8:11], v[128:131], v[96:99], v[8:11]
    ds_read_b64_tr_b16 v[170:171], v246 offset:10240
    v_mfma_f32_16x16x32_bf16 v[24:27], v[128:131], v[100:103], v[24:27]
    ds_read_b128 v[152:155], v244 offset:8192
    v_mfma_f32_16x16x32_bf16 v[40:43], v[128:131], v[104:107], v[40:43]
    ds_read_b64_tr_b16 v[172:173], v247 offset:8192
    v_mfma_f32_16x16x32_bf16 v[56:59], v[128:131], v[108:111], v[56:59]
    ds_read_b128 v[156:159], v244 offset:10240
    v_mfma_f32_16x16x32_bf16 v[72:75], v[128:131], v[112:115], v[72:75]
    s_add_u32 s45, s45, 1024
    s_add_u32 m0, s49, 57344
    s_nop 0
    buffer_load_dwordx4 v254, s[52:55], s45 offen sc1 lds
    v_mfma_f32_16x16x32_bf16 v[88:91], v[128:131], v[116:119], v[88:91]
    ds_read_b64_tr_b16 v[174:175], v247 offset:10240
    v_mfma_f32_16x16x32_bf16 v[92:95], v[132:135], v[116:119], v[92:95]
    v_mfma_f32_16x16x32_bf16 v[76:79], v[132:135], v[112:115], v[76:79]
    v_mfma_f32_16x16x32_bf16 v[60:63], v[132:135], v[108:111], v[60:63]
    s_mov_b32 s45, s95
    s_add_u32 s45, s45, s94
    s_mul_i32 s45, s45, 5120
    s_add_u32 m0, s49, 65536
    s_nop 0
    buffer_load_dwordx4 v254, s[52:55], s45 offen sc1 lds
    v_mfma_f32_16x16x32_bf16 v[44:47], v[132:135], v[104:107], v[44:47]
    v_mfma_f32_16x16x32_bf16 v[28:31], v[132:135], v[100:103], v[28:31]
    v_mfma_f32_16x16x32_bf16 v[12:15], v[132:135], v[96:99], v[12:15]
    s_waitcnt vmcnt(18) lgkmcnt(0)
    s_barrier
    v_mfma_f32_16x16x32_bf16 v[0:3], v[160:163], v[136:139], v[0:3]
    ds_read_b64_tr_b16 v[120:121], v246 offset:16384
    s_lshr_b32 s78, s40, 2
    s_mul_i32 s78, s78, 96
    s_mul_i32 s79, s41, 188
    s_sub_u32 s79, s79, 4
    s_and_b32 s69, s40, 3
    s_lshl_b32 s80, s69, 8
    s_add_u32 s80, s80, 155648
    v_mfma_f32_16x16x32_bf16 v[16:19], v[160:163], v[140:143], v[16:19]
    ds_read_b128 v[96:99], v245 offset:0
    v_mfma_f32_16x16x32_bf16 v[32:35], v[160:163], v[144:147], v[32:35]
    buffer_load_dwordx4 v[188:191], v254, s[52:55], s88 offen offset:1024 sc1
    ds_read_b64_tr_b16 v[122:123], v246 offset:18432
    v_mfma_f32_16x16x32_bf16 v[48:51], v[160:163], v[148:151], v[48:51]
    ds_read_b128 v[100:103], v245 offset:2048
    v_mfma_f32_16x16x32_bf16 v[64:67], v[160:163], v[152:155], v[64:67]
    v_and_b32 v176, 15, v255
    v_add_u32 v176, s78, v176
    v_lshlrev_b32 v180, 4, v176
    v_add_u32 v180, 157696, v180
    v_mfma_f32_16x16x32_bf16 v[80:83], v[160:163], v[156:159], v[80:83]
    ds_read_b64_tr_b16 v[124:125], v247 offset:16384
    s_add_u32 s44, s44, 1024
    s_add_u32 m0, s49, 122880
    s_nop 0
    buffer_load_dwordx4 v254, s[52:55], s44 offen sc1 lds
    v_mfma_f32_16x16x32_bf16 v[84:87], v[164:167], v[156:159], v[84:87]
    ds_read_b128 v[104:107], v245 offset:4096
    v_mfma_f32_16x16x32_bf16 v[68:71], v[164:167], v[152:155], v[68:71]
    v_add_u32 v176, s79, v176
    v_and_b32 v177, 48, v255
    v_add_u32 v178, s80, v177
    v_mfma_f32_16x16x32_bf16 v[52:55], v[164:167], v[148:151], v[52:55]
    ds_read_b64_tr_b16 v[126:127], v247 offset:18432
    ds_read_b64_tr_b16 v[128:129], v246 offset:24576
    v_mfma_f32_16x16x32_bf16 v[36:39], v[164:167], v[144:147], v[36:39]
    ds_read_b128 v[108:111], v245 offset:6144
    v_mfma_f32_16x16x32_bf16 v[20:23], v[164:167], v[140:143], v[20:23]
    s_add_u32 s44, s44, 1024
    s_add_u32 m0, s49, 131072
    s_nop 0
    buffer_load_dwordx4 v254, s[52:55], s44 offen sc1 lds
    v_mfma_f32_16x16x32_bf16 v[4:7], v[164:167], v[136:139], v[4:7]
    s_lshl_b32 s96, s41, 7
    s_add_u32 s96, s96, 2048
    s_cmp_lt_u32 s42, 14
    s_cselect_b32 s96, s96, 8192
    s_lshl_b32 s97, s42, 2
    s_add_u32 s97, s97, s69
    ds_read_b64_tr_b16 v[130:131], v246 offset:26624
    v_mfma_f32_16x16x32_bf16 v[8:11], v[168:171], v[136:139], v[8:11]
    ds_read_b128 v[112:115], v245 offset:8192
    v_mfma_f32_16x16x32_bf16 v[24:27], v[168:171], v[140:143], v[24:27]
    ds_read_b64_tr_b16 v[132:133], v247 offset:24576
    v_mfma_f32_16x16x32_bf16 v[40:43], v[168:171], v[144:147], v[40:43]
    s_add_u32 s71, s97, 20
    s_lshl_b32 s71, s71, 10
    v_ashrrev_i32 v179, 4, v176
    s_mov_b32 s72, 75776
    v_mul_lo_u32 v179, v179, s72
    ds_read_b128 v[116:119], v245 offset:10240
    v_mfma_f32_16x16x32_bf16 v[56:59], v[168:171], v[148:151], v[56:59]
    buffer_load_dwordx4 v[192:195], v254, s[52:55], s88 offen offset:2048 sc1
    v_mfma_f32_16x16x32_bf16 v[72:75], v[168:171], v[152:155], v[72:75]
    ds_read_b64_tr_b16 v[134:135], v247 offset:26624
    v_mfma_f32_16x16x32_bf16 v[88:91], v[168:171], v[156:159], v[88:91]
    v_lshrrev_b32 v177, 2, v177
    v_and_or_b32 v177, v176, 3, v177
    v_and_b32 v181, 12, v176
    v_lshl_add_u32 v177, v181, 2, v177
    v_mfma_f32_16x16x32_bf16 v[92:95], v[172:175], v[156:159], v[92:95]
    v_mfma_f32_16x16x32_bf16 v[76:79], v[172:175], v[152:155], v[76:79]
    buffer_load_dwordx4 v[196:199], v254, s[52:55], s88 offen offset:3072 sc1
    v_mfma_f32_16x16x32_bf16 v[60:63], v[172:175], v[148:151], v[60:63]
    s_cmp_lt_u32 s40, 4
    s_cselect_b32 s74, 0xfff0fff0, -1
    s_mov_b32 s75, s74
    s_mov_b32 s76, 0x00010001
    s_mov_b32 s77, 0x00010001
    v_mfma_f32_16x16x32_bf16 v[44:47], v[172:175], v[144:147], v[44:47]
    v_mfma_f32_16x16x32_bf16 v[28:31], v[172:175], v[140:143], v[28:31]
    s_lshl_b32 s68, s90, 6
    s_mul_i32 s70, s68, 5578
    s_lshr_b32 s70, s70, 20
    s_mul_i32 s47, s68, 5958
    s_lshr_b32 s47, s47, 20
    s_add_u32 s70, s70, 16
    s_add_u32 s47, s47, 32
    v_mov_b32 v250, s70
    v_writelane_b32 v250, s47, 2
    s_add_u32 s68, s68, 63
    s_mul_i32 s70, s68, 5578
    s_lshr_b32 s70, s70, 20
    s_mul_i32 s47, s68, 5958
    s_lshr_b32 s47, s47, 20
    s_add_u32 s70, s70, 16
    s_add_u32 s47, s47, 32
    v_writelane_b32 v250, s70, 1
    v_writelane_b32 v250, s47, 3
    v_lshlrev_b32 v250, 7, v250
    v_mfma_f32_16x16x32_bf16 v[12:15], v[172:175], v[136:139], v[12:15]
    s_waitcnt lgkmcnt(0)
    s_barrier
    v_mfma_f32_16x16x32_bf16 v[0:3], v[120:123], v[96:99], v[0:3]
    v_lshl_add_u32 v247, v177, 4, v179
    v_add_u32 v245, s72, v247
    ds_read_b128 v[136:139], v180 offset:0
    v_mfma_f32_16x16x32_bf16 v[4:7], v[124:127], v[96:99], v[4:7]
    buffer_load_dwordx4 v[200:203], v254, s[52:55], s89 offen sc1
    v_mfma_f32_16x16x32_bf16 v[8:11], v[128:131], v[96:99], v[8:11]
    v_mfma_f32_16x16x32_bf16 v[12:15], v[132:135], v[96:99], v[12:15]
    ds_read_b128 v[140:143], v180 offset:256
    v_mfma_f32_16x16x32_bf16 v[28:31], v[132:135], v[100:103], v[28:31]
    s_cmp_lt_u32 s40, 4
    s_cbranch_scc0 SK_12
    s_mov_b64 exec, s[76:77]
    ds_write_b128 v178, v[0:3] offset:0
    ds_write_b128 v178, v[4:7] offset:64
    ds_write_b128 v178, v[8:11] offset:128
    ds_write_b128 v178, v[12:15] offset:192
    s_mov_b64 exec, -1
SK_12:
    v_mfma_f32_16x16x32_bf16 v[24:27], v[128:131], v[100:103], v[24:27]
    v_mfma_f32_16x16x32_bf16 v[20:23], v[124:127], v[100:103], v[20:23]
    s_add_u32 s44, s44, 1024
    s_add_u32 m0, s49, 139264
    s_nop 0
    buffer_load_dwordx4 v254, s[52:55], s44 offen sc1 lds
    v_mfma_f32_16x16x32_bf16 v[16:19], v[120:123], v[100:103], v[16:19]
    v_mfma_f32_16x16x32_bf16 v[32:35], v[120:123], v[104:107], v[32:35]
    s_waitcnt lgkmcnt(0)
    s_barrier
    ds_read_b128 v[162:165], v178 offset:0
    ds_read_b128 v[166:169], v178 offset:64
    ds_read_b128 v[170:173], v178 offset:128
    ds_read_b128 v[174:177], v178 offset:192
    v_mfma_f32_16x16x32_bf16 v[36:39], v[124:127], v[104:107], v[36:39]
    s_add_u32 s44, s44, 1024
    s_add_u32 m0, s49, 147456
    s_nop 0
    buffer_load_dwordx4 v254, s[52:55], s44 offen sc1 lds
    v_mfma_f32_16x16x32_bf16 v[40:43], v[128:131], v[104:107], v[40:43]
    v_mfma_f32_16x16x32_bf16 v[44:47], v[132:135], v[104:107], v[44:47]
    ds_read_b128 v[144:147], v180 offset:512
    v_mfma_f32_16x16x32_bf16 v[60:63], v[132:135], v[108:111], v[60:63]
    v_mfma_f32_16x16x32_bf16 v[56:59], v[128:131], v[108:111], v[56:59]
    ds_read_b128 v[148:151], v180 offset:768
    v_mfma_f32_16x16x32_bf16 v[52:55], v[124:127], v[108:111], v[52:55]
    s_add_u32 s88, s92, 2
    s_add_u32 s88, s88, s94
    s_mul_i32 s88, s88, 5120
    s_add_u32 s89, s88, 4096
    buffer_load_dwordx4 v[236:239], v254, s[52:55], s88 offen offset:3072 sc1
    v_mfma_f32_16x16x32_bf16 v[48:51], v[120:123], v[108:111], v[48:51]
    v_mfma_f32_16x16x32_bf16 v[64:67], v[120:123], v[112:115], v[64:67]
    ds_read_b128 v[152:155], v180 offset:1024
    v_mfma_f32_16x16x32_bf16 v[68:71], v[124:127], v[112:115], v[68:71]
    v_mfma_f32_16x16x32_bf16 v[72:75], v[128:131], v[112:115], v[72:75]
    ds_read_b128 v[156:159], v180 offset:1280
    v_mfma_f32_16x16x32_bf16 v[76:79], v[132:135], v[112:115], v[76:79]
    buffer_load_dwordx4 v[240:243], v254, s[52:55], s89 offen sc1
    v_mfma_f32_16x16x32_bf16 v[92:95], v[132:135], v[116:119], v[92:95]
    v_mfma_f32_16x16x32_bf16 v[88:91], v[128:131], v[116:119], v[88:91]
    v_mfma_f32_16x16x32_bf16 v[84:87], v[124:127], v[116:119], v[84:87]
    v_mfma_f32_16x16x32_bf16 v[80:83], v[120:123], v[116:119], v[80:83]
    s_cmp_lt_u32 s97, 54
    s_cbranch_scc1 G_EPI
    s_branch G_DONE
G_EPI:
    ds_read_b64 v[96:97], v180 offset:3072
    ds_read_b64 v[98:99], v180 offset:3328
    ds_read_b64 v[100:101], v180 offset:3584
    ds_read_b64 v[102:103], v180 offset:3840
    ds_read_b64 v[104:105], v180 offset:4096
    ds_read_b64 v[106:107], v180 offset:4352
    s_waitcnt lgkmcnt(6)
    v_pk_fma_f32 v[0:1], v[136:137], v[162:163], v[0:1] neg_lo:[1,0,0] neg_hi:[1,0,0]
    v_pk_fma_f32 v[2:3], v[136:137], v[164:165], v[2:3] neg_lo:[1,0,0] neg_hi:[1,0,0]
    v_pk_fma_f32 v[4:5], v[136:137], v[166:167], v[4:5] neg_lo:[1,0,0] neg_hi:[1,0,0]
    v_pk_fma_f32 v[6:7], v[136:137], v[168:169], v[6:7] neg_lo:[1,0,0] neg_hi:[1,0,0]
    v_pk_mul_f32 v[110:111], v[0:1], v[138:139]
    v_pk_mul_f32 v[112:113], v[2:3], v[138:139]
    v_pk_mul_f32 v[114:115], v[4:5], v[138:139]
    v_pk_mul_f32 v[116:117], v[6:7], v[138:139]
    v_exp_f32 v110, v110
    v_pk_fma_f32 v[8:9], v[136:137], v[170:171], v[8:9] neg_lo:[1,0,0] neg_hi:[1,0,0]
    v_exp_f32 v111, v111
    v_pk_mul_f32 v[8:9], v[8:9], v[0:1]
    v_exp_f32 v112, v112
    v_pk_fma_f32 v[10:11], v[136:137], v[172:173], v[10:11] neg_lo:[1,0,0] neg_hi:[1,0,0]
    v_exp_f32 v113, v113
    v_pk_mul_f32 v[10:11], v[10:11], v[2:3]
    v_exp_f32 v114, v114
    v_pk_fma_f32 v[12:13], v[136:137], v[174:175], v[12:13] neg_lo:[1,0,0] neg_hi:[1,0,0]
    v_exp_f32 v115, v115
    v_pk_mul_f32 v[12:13], v[12:13], v[4:5]
    v_exp_f32 v116, v116
    v_pk_fma_f32 v[14:15], v[136:137], v[176:177], v[14:15] neg_lo:[1,0,0] neg_hi:[1,0,0]
    v_exp_f32 v117, v117
    v_pk_mul_f32 v[14:15], v[14:15], v[6:7]
    s_waitcnt lgkmcnt(0)
    v_pk_fma_f32 v[110:111], v[110:111], v[96:97], v[96:97]
    v_pk_fma_f32 v[112:113], v[112:113], v[96:97], v[96:97]
    v_pk_fma_f32 v[114:115], v[114:115], v[96:97], v[96:97]
    v_pk_fma_f32 v[116:117], v[116:117], v[96:97], v[96:97]
    v_rcp_f32 v110, v110
    v_rcp_f32 v111, v111
    v_rcp_f32 v112, v112
    v_rcp_f32 v113, v113
    v_rcp_f32 v114, v114
    v_rcp_f32 v115, v115
    v_rcp_f32 v116, v116
    v_rcp_f32 v117, v117
    v_pk_mul_f32 v[8:9], v[8:9], v[110:111]
    v_pk_mul_f32 v[10:11], v[10:11], v[112:113]
    v_pk_mul_f32 v[12:13], v[12:13], v[114:115]
    v_pk_mul_f32 v[14:15], v[14:15], v[116:117]
    v_cvt_pk_bf16_f32 v0, v8, v9
    v_cvt_pk_bf16_f32 v1, v10, v11
    v_cvt_pk_bf16_f32 v2, v12, v13
    v_cvt_pk_bf16_f32 v3, v14, v15
    s_mov_b64 exec, s[74:75]
    buffer_store_dwordx4 v[0:3], v247, s[36:39], s71 offen sc1
    s_mov_b64 exec, -1
    v_pk_fma_f32 v[16:17], v[140:141], v[162:163], v[16:17] neg_lo:[1,0,0] neg_hi:[1,0,0]
    v_pk_fma_f32 v[18:19], v[140:141], v[164:165], v[18:19] neg_lo:[1,0,0] neg_hi:[1,0,0]
    v_pk_fma_f32 v[20:21], v[140:141], v[166:167], v[20:21] neg_lo:[1,0,0] neg_hi:[1,0,0]
    v_pk_fma_f32 v[22:23], v[140:141], v[168:169], v[22:23] neg_lo:[1,0,0] neg_hi:[1,0,0]
    v_pk_mul_f32 v[110:111], v[16:17], v[142:143]
    v_pk_mul_f32 v[112:113], v[18:19], v[142:143]
    v_pk_mul_f32 v[114:115], v[20:21], v[142:143]
    v_pk_mul_f32 v[116:117], v[22:23], v[142:143]
    v_exp_f32 v110, v110
    v_pk_fma_f32 v[24:25], v[140:141], v[170:171], v[24:25] neg_lo:[1,0,0] neg_hi:[1,0,0]
    v_exp_f32 v111, v111
    v_pk_mul_f32 v[24:25], v[24:25], v[16:17]
    v_exp_f32 v112, v112
    v_pk_fma_f32 v[26:27], v[140:141], v[172:173], v[26:27] neg_lo:[1,0,0] neg_hi:[1,0,0]
    v_exp_f32 v113, v113
    v_pk_mul_f32 v[26:27], v[26:27], v[18:19]
    v_exp_f32 v114, v114
    v_pk_fma_f32 v[28:29], v[140:141], v[174:175], v[28:29] neg_lo:[1,0,0] neg_hi:[1,0,0]
    v_exp_f32 v115, v115
    v_pk_mul_f32 v[28:29], v[28:29], v[20:21]
    v_exp_f32 v116, v116
    v_pk_fma_f32 v[30:31], v[140:141], v[176:177], v[30:31] neg_lo:[1,0,0] neg_hi:[1,0,0]
    v_exp_f32 v117, v117
    v_pk_mul_f32 v[30:31], v[30:31], v[22:23]
    v_pk_fma_f32 v[110:111], v[110:111], v[98:99], v[98:99]
    v_pk_fma_f32 v[112:113], v[112:113], v[98:99], v[98:99]
    v_pk_fma_f32 v[114:115], v[114:115], v[98:99], v[98:99]
    v_pk_fma_f32 v[116:117], v[116:117], v[98:99], v[98:99]
    v_rcp_f32 v110, v110
    v_rcp_f32 v111, v111
    v_rcp_f32 v112, v112
    v_rcp_f32 v113, v113
    v_rcp_f32 v114, v114
    v_rcp_f32 v115, v115
    v_rcp_f32 v116, v116
    v_rcp_f32 v117, v117
    v_pk_mul_f32 v[24:25], v[24:25], v[110:111]
    v_pk_mul_f32 v[26:27], v[26:27], v[112:113]
    v_pk_mul_f32 v[28:29], v[28:29], v[114:115]
    v_pk_mul_f32 v[30:31], v[30:31], v[116:117]
    v_cvt_pk_bf16_f32 v16, v24, v25
    v_cvt_pk_bf16_f32 v17, v26, v27
    v_cvt_pk_bf16_f32 v18, v28, v29
    v_cvt_pk_bf16_f32 v19, v30, v31
    buffer_store_dwordx4 v[16:19], v245, s[36:39], s71 offen sc1
    s_add_u32 s71, s71, s72
    v_pk_fma_f32 v[32:33], v[144:145], v[162:163], v[32:33] neg_lo:[1,0,0] neg_hi:[1,0,0]
    v_pk_fma_f32 v[34:35], v[144:145], v[164:165], v[34:35] neg_lo:[1,0,0] neg_hi:[1,0,0]
    v_pk_fma_f32 v[36:37], v[144:145], v[166:167], v[36:37] neg_lo:[1,0,0] neg_hi:[1,0,0]
    v_pk_fma_f32 v[38:39], v[144:145], v[168:169], v[38:39] neg_lo:[1,0,0] neg_hi:[1,0,0]
    v_pk_mul_f32 v[110:111], v[32:33], v[146:147]
    v_pk_mul_f32 v[112:113], v[34:35], v[146:147]
    v_pk_mul_f32 v[114:115], v[36:37], v[146:147]
    v_pk_mul_f32 v[116:117], v[38:39], v[146:147]
    v_exp_f32 v110, v110
    v_pk_fma_f32 v[40:41], v[144:145], v[170:171], v[40:41] neg_lo:[1,0,0] neg_hi:[1,0,0]
    v_exp_f32 v111, v111
    v_pk_mul_f32 v[40:41], v[40:41], v[32:33]
    v_exp_f32 v112, v112
    v_pk_fma_f32 v[42:43], v[144:145], v[172:173], v[42:43] neg_lo:[1,0,0] neg_hi:[1,0,0]
    v_exp_f32 v113, v113
    v_pk_mul_f32 v[42:43], v[42:43], v[34:35]
    v_exp_f32 v114, v114
    v_pk_fma_f32 v[44:45], v[144:145], v[174:175], v[44:45] neg_lo:[1,0,0] neg_hi:[1,0,0]
    v_exp_f32 v115, v115
    v_pk_mul_f32 v[44:45], v[44:45], v[36:37]
    v_exp_f32 v116, v116
    v_pk_fma_f32 v[46:47], v[144:145], v[176:177], v[46:47] neg_lo:[1,0,0] neg_hi:[1,0,0]
    v_exp_f32 v117, v117
    v_pk_mul_f32 v[46:47], v[46:47], v[38:39]
    v_pk_fma_f32 v[110:111], v[110:111], v[100:101], v[100:101]
    v_pk_fma_f32 v[112:113], v[112:113], v[100:101], v[100:101]
    v_pk_fma_f32 v[114:115], v[114:115], v[100:101], v[100:101]
    v_pk_fma_f32 v[116:117], v[116:117], v[100:101], v[100:101]
    v_rcp_f32 v110, v110
    v_rcp_f32 v111, v111
    v_rcp_f32 v112, v112
    v_rcp_f32 v113, v113
    v_rcp_f32 v114, v114
    v_rcp_f32 v115, v115
    v_rcp_f32 v116, v116
    v_rcp_f32 v117, v117
    v_pk_mul_f32 v[40:41], v[40:41], v[110:111]
    v_pk_mul_f32 v[42:43], v[42:43], v[112:113]
    v_pk_mul_f32 v[44:45], v[44:45], v[114:115]
    v_pk_mul_f32 v[46:47], v[46:47], v[116:117]
    v_cvt_pk_bf16_f32 v32, v40, v41
    v_cvt_pk_bf16_f32 v33, v42, v43
    v_cvt_pk_bf16_f32 v34, v44, v45
    v_cvt_pk_bf16_f32 v35, v46, v47
    buffer_store_dwordx4 v[32:35], v245, s[36:39], s71 offen sc1
    s_add_u32 s71, s71, s72
    v_pk_fma_f32 v[48:49], v[148:149], v[162:163], v[48:49] neg_lo:[1,0,0] neg_hi:[1,0,0]
    v_pk_fma_f32 v[50:51], v[148:149], v[164:165], v[50:51] neg_lo:[1,0,0] neg_hi:[1,0,0]
    v_pk_fma_f32 v[52:53], v[148:149], v[166:167], v[52:53] neg_lo:[1,0,0] neg_hi:[1,0,0]
    v_pk_fma_f32 v[54:55], v[148:149], v[168:169], v[54:55] neg_lo:[1,0,0] neg_hi:[1,0,0]
    v_pk_mul_f32 v[110:111], v[48:49], v[150:151]
    v_pk_mul_f32 v[112:113], v[50:51], v[150:151]
    v_pk_mul_f32 v[114:115], v[52:53], v[150:151]
    v_pk_mul_f32 v[116:117], v[54:55], v[150:151]
    v_exp_f32 v110, v110
    v_pk_fma_f32 v[56:57], v[148:149], v[170:171], v[56:57] neg_lo:[1,0,0] neg_hi:[1,0,0]
    v_exp_f32 v111, v111
    v_pk_mul_f32 v[56:57], v[56:57], v[48:49]
    v_exp_f32 v112, v112
    v_pk_fma_f32 v[58:59], v[148:149], v[172:173], v[58:59] neg_lo:[1,0,0] neg_hi:[1,0,0]
    v_exp_f32 v113, v113
    v_pk_mul_f32 v[58:59], v[58:59], v[50:51]
    v_exp_f32 v114, v114
    v_pk_fma_f32 v[60:61], v[148:149], v[174:175], v[60:61] neg_lo:[1,0,0] neg_hi:[1,0,0]
    v_exp_f32 v115, v115
    v_pk_mul_f32 v[60:61], v[60:61], v[52:53]
    v_exp_f32 v116, v116
    v_pk_fma_f32 v[62:63], v[148:149], v[176:177], v[62:63] neg_lo:[1,0,0] neg_hi:[1,0,0]
    v_exp_f32 v117, v117
    v_pk_mul_f32 v[62:63], v[62:63], v[54:55]
    v_pk_fma_f32 v[110:111], v[110:111], v[102:103], v[102:103]
    v_pk_fma_f32 v[112:113], v[112:113], v[102:103], v[102:103]
    v_pk_fma_f32 v[114:115], v[114:115], v[102:103], v[102:103]
    v_pk_fma_f32 v[116:117], v[116:117], v[102:103], v[102:103]
    v_rcp_f32 v110, v110
    v_rcp_f32 v111, v111
    v_rcp_f32 v112, v112
    v_rcp_f32 v113, v113
    v_rcp_f32 v114, v114
    v_rcp_f32 v115, v115
    v_rcp_f32 v116, v116
    v_rcp_f32 v117, v117
    v_pk_mul_f32 v[56:57], v[56:57], v[110:111]
    v_pk_mul_f32 v[58:59], v[58:59], v[112:113]
    v_pk_mul_f32 v[60:61], v[60:61], v[114:115]
    v_pk_mul_f32 v[62:63], v[62:63], v[116:117]
    v_cvt_pk_bf16_f32 v48, v56, v57
    v_cvt_pk_bf16_f32 v49, v58, v59
    v_cvt_pk_bf16_f32 v50, v60, v61
    v_cvt_pk_bf16_f32 v51, v62, v63
    buffer_store_dwordx4 v[48:51], v245, s[36:39], s71 offen sc1
    s_add_u32 s71, s71, s72
    v_pk_fma_f32 v[64:65], v[152:153], v[162:163], v[64:65] neg_lo:[1,0,0] neg_hi:[1,0,0]
    v_pk_fma_f32 v[66:67], v[152:153], v[164:165], v[66:67] neg_lo:[1,0,0] neg_hi:[1,0,0]
    v_pk_fma_f32 v[68:69], v[152:153], v[166:167], v[68:69] neg_lo:[1,0,0] neg_hi:[1,0,0]
    v_pk_fma_f32 v[70:71], v[152:153], v[168:169], v[70:71] neg_lo:[1,0,0] neg_hi:[1,0,0]
    v_pk_mul_f32 v[110:111], v[64:65], v[154:155]
    v_pk_mul_f32 v[112:113], v[66:67], v[154:155]
    v_pk_mul_f32 v[114:115], v[68:69], v[154:155]
    v_pk_mul_f32 v[116:117], v[70:71], v[154:155]
    v_exp_f32 v110, v110
    v_pk_fma_f32 v[72:73], v[152:153], v[170:171], v[72:73] neg_lo:[1,0,0] neg_hi:[1,0,0]
    v_exp_f32 v111, v111
    v_pk_mul_f32 v[72:73], v[72:73], v[64:65]
    v_exp_f32 v112, v112
    v_pk_fma_f32 v[74:75], v[152:153], v[172:173], v[74:75] neg_lo:[1,0,0] neg_hi:[1,0,0]
    v_exp_f32 v113, v113
    v_pk_mul_f32 v[74:75], v[74:75], v[66:67]
    v_exp_f32 v114, v114
    v_pk_fma_f32 v[76:77], v[152:153], v[174:175], v[76:77] neg_lo:[1,0,0] neg_hi:[1,0,0]
    v_exp_f32 v115, v115
    v_pk_mul_f32 v[76:77], v[76:77], v[68:69]
    v_exp_f32 v116, v116
    v_pk_fma_f32 v[78:79], v[152:153], v[176:177], v[78:79] neg_lo:[1,0,0] neg_hi:[1,0,0]
    v_exp_f32 v117, v117
    v_pk_mul_f32 v[78:79], v[78:79], v[70:71]
    v_pk_fma_f32 v[110:111], v[110:111], v[104:105], v[104:105]
    v_pk_fma_f32 v[112:113], v[112:113], v[104:105], v[104:105]
    v_pk_fma_f32 v[114:115], v[114:115], v[104:105], v[104:105]
    v_pk_fma_f32 v[116:117], v[116:117], v[104:105], v[104:105]
    v_rcp_f32 v110, v110
    v_rcp_f32 v111, v111
    v_rcp_f32 v112, v112
    v_rcp_f32 v113, v113
    v_rcp_f32 v114, v114
    v_rcp_f32 v115, v115
    v_rcp_f32 v116, v116
    v_rcp_f32 v117, v117
    v_pk_mul_f32 v[72:73], v[72:73], v[110:111]
    v_pk_mul_f32 v[74:75], v[74:75], v[112:113]
    v_pk_mul_f32 v[76:77], v[76:77], v[114:115]
    v_pk_mul_f32 v[78:79], v[78:79], v[116:117]
    v_cvt_pk_bf16_f32 v64, v72, v73
    v_cvt_pk_bf16_f32 v65, v74, v75
    v_cvt_pk_bf16_f32 v66, v76, v77
    v_cvt_pk_bf16_f32 v67, v78, v79
    buffer_store_dwordx4 v[64:67], v245, s[36:39], s71 offen sc1
    s_add_u32 s71, s71, s72
    v_pk_fma_f32 v[80:81], v[156:157], v[162:163], v[80:81] neg_lo:[1,0,0] neg_hi:[1,0,0]
    v_pk_fma_f32 v[82:83], v[156:157], v[164:165], v[82:83] neg_lo:[1,0,0] neg_hi:[1,0,0]
    v_pk_fma_f32 v[84:85], v[156:157], v[166:167], v[84:85] neg_lo:[1,0,0] neg_hi:[1,0,0]
    v_pk_fma_f32 v[86:87], v[156:157], v[168:169], v[86:87] neg_lo:[1,0,0] neg_hi:[1,0,0]
    v_pk_mul_f32 v[110:111], v[80:81], v[158:159]
    v_pk_mul_f32 v[112:113], v[82:83], v[158:159]
    v_pk_mul_f32 v[114:115], v[84:85], v[158:159]
    v_pk_mul_f32 v[116:117], v[86:87], v[158:159]
    v_exp_f32 v110, v110
    v_pk_fma_f32 v[88:89], v[156:157], v[170:171], v[88:89] neg_lo:[1,0,0] neg_hi:[1,0,0]
    v_exp_f32 v111, v111
    v_pk_mul_f32 v[88:89], v[88:89], v[80:81]
    v_exp_f32 v112, v112
    v_pk_fma_f32 v[90:91], v[156:157], v[172:173], v[90:91] neg_lo:[1,0,0] neg_hi:[1,0,0]
    v_exp_f32 v113, v113
    v_pk_mul_f32 v[90:91], v[90:91], v[82:83]
    v_exp_f32 v114, v114
    v_pk_fma_f32 v[92:93], v[156:157], v[174:175], v[92:93] neg_lo:[1,0,0] neg_hi:[1,0,0]
    v_exp_f32 v115, v115
    v_pk_mul_f32 v[92:93], v[92:93], v[84:85]
    v_exp_f32 v116, v116
    v_pk_fma_f32 v[94:95], v[156:157], v[176:177], v[94:95] neg_lo:[1,0,0] neg_hi:[1,0,0]
    v_exp_f32 v117, v117
    v_pk_mul_f32 v[94:95], v[94:95], v[86:87]
    v_pk_fma_f32 v[110:111], v[110:111], v[106:107], v[106:107]
    v_pk_fma_f32 v[112:113], v[112:113], v[106:107], v[106:107]
    v_pk_fma_f32 v[114:115], v[114:115], v[106:107], v[106:107]
    v_pk_fma_f32 v[116:117], v[116:117], v[106:107], v[106:107]
    v_rcp_f32 v110, v110
    v_rcp_f32 v111, v111
    v_rcp_f32 v112, v112
    v_rcp_f32 v113, v113
    v_rcp_f32 v114, v114
    v_rcp_f32 v115, v115
    v_rcp_f32 v116, v116
    v_rcp_f32 v117, v117
    v_pk_mul_f32 v[88:89], v[88:89], v[110:111]
    v_pk_mul_f32 v[90:91], v[90:91], v[112:113]
    v_pk_mul_f32 v[92:93], v[92:93], v[114:115]
    v_pk_mul_f32 v[94:95], v[94:95], v[116:117]
    v_cvt_pk_bf16_f32 v80, v88, v89
    v_cvt_pk_bf16_f32 v81, v90, v91
    v_cvt_pk_bf16_f32 v82, v92, v93
    v_cvt_pk_bf16_f32 v83, v94, v95
    buffer_store_dwordx4 v[80:83], v245, s[36:39], s71 offen sc1
    s_add_u32 s71, s71, s72
G_DONE:
    s_cmp_eq_u32 s40, 3
    s_cbranch_scc0 SK_14
    s_mov_b64 exec, 15
    buffer_load_dword v252, v250, s[60:63], 0 offen sc1
    s_mov_b64 exec, -1
SK_14:
    s_waitcnt vmcnt(0) lgkmcnt(0)
    s_barrier
    s_cmp_eq_u32 s40, 0
    s_cbranch_scc0 SK_15
    v_mov_b32 v253, 1
    s_mov_b64 exec, 1
    buffer_atomic_add v253, off, s[60:63], s96 sc1
    s_mov_b64 exec, -1
SK_15:
    s_branch P2_ENTRY
QKV:
    s_mul_i32 s70, s42, 160
    v_add_u32 v236, 0, v0
    v_mul_u32_u24 v237, 2185, v236
    v_lshrrev_b32 v237, 16, v237
    v_mul_u32_u24 v238, 30, v237
    v_sub_u32 v238, v236, v238
    v_mul_u32_u24 v239, 6554, v238
    v_lshrrev_b32 v239, 16, v239
    v_mul_u32_u24 v240, 1120, v239
    v_lshl_add_u32 v240, v238, 4, v240
    v_and_b32 v238, 3, v237
    v_and_b32 v239, 12, v237
    v_lshl_add_u32 v238, v239, 1, v238
    v_bfe_u32 v239, v237, 4, 1
    v_lshl_add_u32 v238, v239, 2, v238
    v_mul_u32_u24 v238, 3840, v238
    v_add3_u32 v187, v238, v240, s70
    v_add_u32 v236, 512, v0
    v_mul_u32_u24 v237, 2185, v236
    v_lshrrev_b32 v237, 16, v237
    v_mul_u32_u24 v238, 30, v237
    v_sub_u32 v238, v236, v238
    v_mul_u32_u24 v239, 6554, v238
    v_lshrrev_b32 v239, 16, v239
    v_mul_u32_u24 v240, 1120, v239
    v_lshl_add_u32 v240, v238, 4, v240
    v_and_b32 v238, 3, v237
    v_and_b32 v239, 12, v237
    v_lshl_add_u32 v238, v239, 1, v238
    v_bfe_u32 v239, v237, 4, 1
    v_lshl_add_u32 v238, v239, 2, v238
    v_mul_u32_u24 v238, 3840, v238
    v_add3_u32 v188, v238, v240, s70
    v_cmp_gt_u32 vcc, 32, v237
    v_mov_b32 v238, 0x80000000
    s_nop 0
    v_cndmask_b32 v188, v238, v188, vcc
    s_lshl_b32 s47, s40, 10
    s_add_u32 s47, s47, 73728
    s_add_u32 s48, s47, 8192
    s_mov_b32 s45, 122880
    v_lshrrev_b32 v236, 3, v255
    v_and_b32 v237, 7, v255
    v_lshrrev_b32 v238, 1, v236
    s_and_b32 s68, s40, 1
    s_lshl_b32 s69, s68, 2
    v_or_b32 v238, s69, v238
    v_xor_b32 v237, v237, v238
    s_mul_i32 s69, s41, 176
    s_lshr_b32 s70, s40, 1
    s_lshl_b32 s71, s70, 4
    s_add_u32 s69, s69, s71
    s_and_b32 s70, s70, 1
    s_xor_b32 s70, s70, s68
    s_add_u32 s69, s69, s70
    s_sub_u32 s69, s69, 16
    v_lshl_add_u32 v236, v236, 1, s69
    v_mul_i32_i24 v236, 1280, v236
    v_lshl_add_u32 v184, v237, 4, v236
    v_add_u32 v185, 81920, v184
    v_add_u32 v186, 163840, v184
    s_lshl_b32 s49, s40, 10
    s_cmp_eq_u32 s40, 0
    s_cselect_b32 s56, 0xffffff00, -1
    s_mov_b32 s57, -1
    s_mov_b32 s32, s22
    s_mov_b32 s33, s23
    s_mov_b32 s34, 32768
    s_mov_b32 s35, 0x20000
    s_add_u32 s36, s22, 3145728
    s_addc_u32 s37, s23, 0
    s_mov_b32 s38, 9699328
    s_mov_b32 s39, 0x20000
    s_add_u32 s52, s22, 65536
    s_addc_u32 s53, s23, 0
    s_mov_b32 s54, 3031040
    s_mov_b32 s55, 0x20000
    s_add_u32 s60, s22, 32768
    s_addc_u32 s61, s23, 0
    s_mov_b32 s62, 8192
    s_mov_b32 s63, 0x20000
    s_mov_b32 s64, s20
    s_mov_b32 s65, s21
    s_mov_b32 s66, 256
    s_mov_b32 s67, 0x20000
    v_mov_b32 v236, 0x3f803f80
    v_mov_b32 v237, 0x3f803f80
    v_mov_b32 v238, 0x3f803f80
    v_mov_b32 v239, 0x3f803f80
    s_mov_b64 exec, 0xff
    ds_write_b128 v254, v[236:239] offset:0
    ds_write_b128 v254, v[236:239] offset:24576
    ds_write_b128 v254, v[236:239] offset:49152
    s_mov_b64 exec, -1
    v_and_b32 v240, 15, v255
    v_lshrrev_b32 v241, 4, v255
    v_lshrrev_b32 v242, 1, v240
    v_xor_b32 v241, v241, v242
    v_lshlrev_b32 v241, 4, v241
    v_lshl_add_u32 v240, v240, 7, v241
    s_and_b32 s68, s40, 3
    s_mul_i32 s68, s68, 6144
    v_add_u32 v244, s68, v240
    v_xor_b32 v245, 64, v244
    s_and_b32 s68, s2, 7
    s_lshr_b32 s71, s2, 3
    s_lshl_b32 s90, s68, 2
    s_lshr_b32 s68, s71, 3
    s_add_u32 s90, s90, s68
    s_and_b32 s91, s71, 7
    s_mul_i32 s92, s40, 6
    s_add_u32 s92, s92, 20
    s_lshl_b32 s93, s40, 1
    s_sub_u32 s93, s93, 7
    s_add_u32 s95, s40, 68
    s_add_u32 s68, s40, 10
    s_cmp_lt_u32 s40, 6
    s_cselect_b32 s95, s95, s68
    s_add_u32 s50, s40, 18
    s_mul_i32 s94, s91, 74
    s_lshr_b32 s59, s40, 1
    s_mul_i32 s58, s59, 96
    s_add_u32 s58, s58, s2
    s_add_u32 s58, s58, 640
    s_min_u32 s88, s58, 740
    s_mul_i32 s58, s88, 6554
    s_lshr_b32 s58, s58, 16
    s_mul_i32 s89, s58, 10
    s_sub_u32 s89, s88, s89
    s_sub_u32 s80, s58, 20
    s_lshl_b32 s80, s80, 5
    s_mul_i32 s81, s58, 40
    s_mul_i32 s82, s58, 160
    s_sub_u32 s82, s82, 2544
    s_cmp_lt_u32 s58, 16
    s_cselect_b32 s81, s81, s82
    s_cselect_b32 s83, 4, 40
    s_cmp_lt_u32 s58, 20
    s_cselect_b32 s80, s81, s80
    s_cselect_b32 s83, s83, 4
    s_cselect_b32 s81, 20, 16
    s_cselect_b32 s84, s8, s16
    s_cselect_b32 s85, s9, s17
    s_mov_b32 s86, 2211840
    s_cselect_b32 s86, 819200, s86
    s_mov_b32 s87, 0x20000
    s_and_b32 s82, s40, 1
    s_mul_i32 s88, s82, s83
    s_lshl_b32 s88, s88, 1
    s_add_u32 s80, s80, s88
    s_mul_i32 s80, s80, 1280
    s_lshl_b32 s88, s89, 7
    s_add_u32 s80, s80, s88
    s_mul_i32 s81, s81, 1280
    s_add_u32 s81, s81, s80
    v_lshrrev_b32 v224, 5, v255
    v_mul_u32_u24 v224, s83, v224
    v_bfe_u32 v225, v255, 3, 2
    v_add_u32 v224, v224, v225
    v_mul_u32_u24 v224, 1280, v224
    v_lshrrev_b32 v225, 3, v255
    v_and_b32 v225, 6, v225
    v_xor_b32 v225, v225, v255
    v_and_b32 v225, 7, v225
    v_lshl_add_u32 v224, v225, 4, v224
    s_lshl_b32 s59, s59, 12
    s_add_u32 s59, s59, 139264
    s_lshl_b32 s83, s82, 10
    s_add_u32 s83, s83, s59
    v_bfe_u32 v226, v255, 2, 3
    v_lshrrev_b32 v225, 5, v255
    v_lshlrev_b32 v225, 10, v225
    v_lshl_add_u32 v225, v226, 7, v225
    v_and_b32 v227, 3, v255
    v_lshl_add_u32 v225, v227, 3, v225
    v_lshrrev_b32 v226, 1, v226
    s_lshl_b32 s82, s82, 1
    v_xor_b32 v226, s82, v226
    v_lshl_add_u32 v225, v226, 5, v225
    v_add_u32 v225, s59, v225
    v_xor_b32 v226, 32, v225
    s_lshl_b32 s89, s89, 2
    s_add_u32 s89, s89, s82
    s_mul_i32 s82, s58, 5
    s_mul_i32 s88, s89, 13108
    s_lshr_b32 s88, s88, 16
    s_mul_i32 s88, s88, 365
    s_add_u32 s88, s88, s89
    s_add_u32 s88, s88, s82
    s_lshl_b32 s88, s88, 10
    s_cmp_lt_u32 s58, 74
    s_cselect_b32 s76, s88, 3031040
    s_add_u32 s89, s89, 1
    s_mul_i32 s88, s89, 13108
    s_lshr_b32 s88, s88, 16
    s_mul_i32 s88, s88, 365
    s_add_u32 s88, s88, s89
    s_add_u32 s88, s88, s82
    s_lshl_b32 s88, s88, 10
    s_cmp_lt_u32 s58, 74
    s_cselect_b32 s77, s88, 3031040
    v_lshrrev_b32 v236, 2, v255
    v_mul_u32_u24 v236, 480, v236
    s_lshr_b32 s68, s40, 2
    s_mul_i32 s68, s68, 80
    s_add_u32 s68, s68, 73728
    v_add_u32 v236, s68, v236
    v_and_b32 v237, 3, v255
    v_lshl_add_u32 v246, v237, 3, v236
    v_and_b32 v238, 1, v255
    v_mul_u32_u24 v238, 40, v238
    v_add3_u32 v238, v238, v236, 32
    v_mul_u32_u24 v248, 40, v237
    v_add3_u32 v248, v248, v236, 32
    v_add_u32 v248, 320, v248
    v_bfe_u32 v237, v255, 1, 1
    v_mul_u32_u24 v237, 160, v237
    v_add_u32 v247, v237, v238
    s_add_u32 m0, s83, 0
    s_nop 0
    buffer_load_dwordx4 v224, s[84:87], s80 offen lds
    s_add_u32 m0, s83, 2048
    s_nop 0
    buffer_load_dwordx4 v224, s[84:87], s81 offen lds
    s_add_u32 m0, s47, 0
    s_mul_i32 s44, s45, 0
    buffer_load_dwordx4 v187, s[28:31], s44 offen lds
    s_add_u32 m0, s48, 0
    s_mul_i32 s44, s45, 0
    buffer_load_dwordx4 v188, s[28:31], s44 offen lds
    s_add_u32 m0, s49, 0
    s_movk_i32 s46, 0
    s_mov_b64 exec, s[56:57]
    buffer_load_dwordx4 v184, s[24:27], s46 offen lds
    s_mov_b64 exec, -1
    s_add_u32 m0, s49, 8192
    s_movk_i32 s46, 0
    buffer_load_dwordx4 v185, s[24:27], s46 offen lds
    s_add_u32 m0, s49, 16384
    s_movk_i32 s46, 0
    buffer_load_dwordx4 v186, s[24:27], s46 offen lds
    s_barrier
    s_add_u32 m0, s47, 16384
    s_mul_i32 s44, s45, 1
    buffer_load_dwordx4 v187, s[28:31], s44 offen lds
    s_add_u32 m0, s48, 16384
    s_mul_i32 s44, s45, 1
    buffer_load_dwordx4 v188, s[28:31], s44 offen lds
    s_waitcnt vmcnt(10)
    v_lshlrev_b32 v202, 16, v196
    v_and_b32 v203, 0xffff0000, v196
    v_lshlrev_b32 v204, 16, v197
    v_and_b32 v205, 0xffff0000, v197
    v_lshlrev_b32 v206, 16, v198
    v_and_b32 v207, 0xffff0000, v198
    v_lshlrev_b32 v208, 16, v199
    v_and_b32 v209, 0xffff0000, v199
    v_lshlrev_b32 v210, 16, v200
    v_and_b32 v211, 0xffff0000, v200
    v_readfirstlane_b32 s78, v202
    v_readfirstlane_b32 s79, v202
    s_nop 1
    v_pk_add_f32 v[202:203], v[202:203], s[78:79] neg_lo:[0,1] neg_hi:[0,1]
    v_pk_add_f32 v[204:205], v[204:205], s[78:79] neg_lo:[0,1] neg_hi:[0,1]
    v_pk_add_f32 v[206:207], v[206:207], s[78:79] neg_lo:[0,1] neg_hi:[0,1]
    v_pk_add_f32 v[208:209], v[208:209], s[78:79] neg_lo:[0,1] neg_hi:[0,1]
    v_pk_add_f32 v[210:211], v[210:211], s[78:79] neg_lo:[0,1] neg_hi:[0,1]
    v_pk_add_f32 v[212:213], v[202:203], v[204:205]
    v_pk_mul_f32 v[214:215], v[202:203], v[202:203]
    v_pk_fma_f32 v[214:215], v[204:205], v[204:205], v[214:215]
    v_pk_fma_f32 v[214:215], v[206:207], v[206:207], v[214:215]
    v_pk_add_f32 v[212:213], v[212:213], v[206:207]
    v_pk_fma_f32 v[214:215], v[208:209], v[208:209], v[214:215]
    v_pk_add_f32 v[212:213], v[212:213], v[208:209]
    v_pk_fma_f32 v[214:215], v[210:211], v[210:211], v[214:215]
    v_pk_add_f32 v[212:213], v[212:213], v[210:211]
    v_add_f32 v212, v212, v213
    v_add_f32 v214, v214, v215
    s_nop 1
    v_permlane32_swap_b32 v212, v214
    v_add_f32 v212, v212, v214
    s_nop 1
    v_add_f32_dpp v212, v212, v212 quad_perm:[1,0,3,2] row_mask:0xf bank_mask:0xf
    s_nop 1
    v_add_f32_dpp v212, v212, v212 quad_perm:[2,3,0,1] row_mask:0xf bank_mask:0xf
    s_nop 1
    v_add_f32_dpp v212, v212, v212 row_half_mirror row_mask:0xf bank_mask:0xf
    s_nop 1
    v_add_f32_dpp v212, v212, v212 row_mirror row_mask:0xf bank_mask:0xf
    v_mov_b32 v201, v212
    s_nop 1
    v_permlane16_swap_b32 v212, v201
    v_add_f32 v212, v212, v201
    v_mul_f32 v212, 0x3acccccd, v212
    s_nop 0
    v_readlane_b32 s79, v212, 32
    s_nop 1
    v_fma_f32 v214, -v212, v212, s79
    v_add_f32 v212, s78, v212
    v_max_f32 v214, 0, v214
    v_cvt_pk_bf16_f32 v212, v212, v212
    v_and_b32 v212, 0xffff0000, v212
    v_cvt_pk_bf16_f32 v214, v214, v214
    v_and_b32 v214, 0xffff0000, v214
    v_add_f32 v214, 0x3727c5ac, v214
    v_cvt_pk_bf16_f32 v214, v214, v214
    v_and_b32 v214, 0xffff0000, v214
    v_sqrt_f32 v214, v214
    s_nop 0
    v_cvt_pk_bf16_f32 v214, v214, v214
    v_and_b32 v214, 0xffff0000, v214
    v_rcp_f32 v213, v214
    v_mul_f32 v215, v214, v214
    v_mul_f32 v214, 0xbfb8aa3b, v213
    s_waitcnt vmcnt(2) lgkmcnt(0)
    s_barrier
    ds_read_b64_tr_b16 v[108:109], v246 offset:0
    ds_read_b64_tr_b16 v[110:111], v246 offset:7680
    s_add_u32 m0, s47, 32768
    s_mul_i32 s44, s45, 2
    buffer_load_dwordx4 v187, s[28:31], s44 offen lds
    ds_read_b64_tr_b16 v[112:113], v246 offset:40
    ds_read_b128 v[96:99], v244 offset:0
    ds_read_b64_tr_b16 v[114:115], v246 offset:7720
    ds_read_b64_tr_b16 v[116:117], v246 offset:160
    s_add_u32 m0, s48, 32768
    s_mul_i32 s44, s45, 2
    buffer_load_dwordx4 v188, s[28:31], s44 offen lds
    ds_read_b64_tr_b16 v[118:119], v246 offset:7840
    ds_read_b64_tr_b16 v[120:121], v246 offset:200
    ds_read_b64_tr_b16 v[122:123], v246 offset:7880
    ds_read_b128 v[100:103], v244 offset:2048
    s_add_u32 m0, s49, 24576
    s_movk_i32 s46, 128
    s_mov_b64 exec, s[56:57]
    buffer_load_dwordx4 v184, s[24:27], s46 offen lds
    s_mov_b64 exec, -1
    ds_read_b64_tr_b16 v[124:125], v247 offset:0
    ds_read_b64_tr_b16 v[126:127], v247 offset:7680
    ds_read_b64_tr_b16 v[128:129], v246 offset:320
    s_add_u32 m0, s49, 32768
    s_movk_i32 s46, 128
    buffer_load_dwordx4 v185, s[24:27], s46 offen lds
    ds_read_b64_tr_b16 v[130:131], v246 offset:8000
    ds_read_b64_tr_b16 v[132:133], v246 offset:360
    ds_read_b128 v[104:107], v244 offset:4096
    ds_read_b64_tr_b16 v[134:135], v246 offset:8040
    s_add_u32 m0, s49, 40960
    s_movk_i32 s46, 128
    buffer_load_dwordx4 v186, s[24:27], s46 offen lds
    ds_read_b64_tr_b16 v[136:137], v248 offset:0
    ds_read_b64_tr_b16 v[138:139], v248 offset:7680
    s_waitcnt vmcnt(5) lgkmcnt(0)
    s_barrier
    s_cmp_lt_u32 s40, 4
    s_cbranch_scc0 SK_26
    v_mfma_f32_16x16x32_bf16 v[28:31], v[96:99], v[136:139], 0
    ds_read_b64_tr_b16 v[180:181], v248 offset:16384
    v_mfma_f32_16x16x32_bf16 v[60:63], v[100:103], v[136:139], 0
    ds_read_b64_tr_b16 v[182:183], v248 offset:24064
    v_mfma_f32_16x16x32_bf16 v[92:95], v[104:107], v[136:139], 0
SK_26:
    v_mfma_f32_16x16x32_bf16 v[0:3], v[108:111], v[96:99], 0
    ds_read_b64_tr_b16 v[152:153], v246 offset:16384
    ds_read_b64_tr_b16 v[154:155], v246 offset:24064
    v_mfma_f32_16x16x32_bf16 v[4:7], v[112:115], v[96:99], 0
    ds_read_b64_tr_b16 v[156:157], v246 offset:16424
    s_add_u32 m0, s47, 49152
    s_mul_i32 s44, s45, 3
    buffer_load_dwordx4 v187, s[28:31], s44 offen lds
    v_mfma_f32_16x16x32_bf16 v[8:11], v[116:119], v[96:99], 0
    ds_read_b64_tr_b16 v[216:217], v225 offset:0
    v_mfma_f32_16x16x32_bf16 v[12:15], v[120:123], v[96:99], 0
    ds_read_b128 v[140:143], v245 offset:0
    ds_read_b64_tr_b16 v[158:159], v246 offset:24104
    v_mfma_f32_16x16x32_bf16 v[16:19], v[124:127], v[96:99], 0
    ds_read_b64_tr_b16 v[160:161], v246 offset:16544
    v_mfma_f32_16x16x32_bf16 v[20:23], v[96:99], v[128:131], 0
    ds_read_b64_tr_b16 v[162:163], v246 offset:24224
    ds_read_b64_tr_b16 v[164:165], v246 offset:16584
    v_mfma_f32_16x16x32_bf16 v[24:27], v[96:99], v[132:135], 0
    s_add_u32 m0, s48, 49152
    s_mul_i32 s44, s45, 3
    buffer_load_dwordx4 v188, s[28:31], s44 offen lds
    v_mfma_f32_16x16x32_bf16 v[56:59], v[100:103], v[132:135], 0
    ds_read_b64_tr_b16 v[218:219], v225 offset:2048
    ds_read_b64_tr_b16 v[166:167], v246 offset:24264
    v_mfma_f32_16x16x32_bf16 v[52:55], v[100:103], v[128:131], 0
    ds_read_b128 v[144:147], v245 offset:2048
    v_mfma_f32_16x16x32_bf16 v[48:51], v[124:127], v[100:103], 0
    ds_read_b64_tr_b16 v[168:169], v247 offset:16384
    ds_read_b64_tr_b16 v[170:171], v247 offset:24064
    v_mfma_f32_16x16x32_bf16 v[44:47], v[120:123], v[100:103], 0
    ds_read_b64_tr_b16 v[172:173], v246 offset:16704
    ds_read_b64_tr_b16 v[174:175], v246 offset:24384
    v_mfma_f32_16x16x32_bf16 v[40:43], v[116:119], v[100:103], 0
    s_add_u32 m0, s49, 49152
    s_movk_i32 s46, 256
    s_mov_b64 exec, s[56:57]
    buffer_load_dwordx4 v184, s[24:27], s46 offen lds
    s_mov_b64 exec, -1
    v_mfma_f32_16x16x32_bf16 v[36:39], v[112:115], v[100:103], 0
    ds_read_b64_tr_b16 v[220:221], v226 offset:0
    ds_read_b64_tr_b16 v[176:177], v246 offset:16744
    v_mfma_f32_16x16x32_bf16 v[32:35], v[108:111], v[100:103], 0
    ds_read_b128 v[148:151], v245 offset:4096
    v_mfma_f32_16x16x32_bf16 v[64:67], v[108:111], v[104:107], 0
    ds_read_b64_tr_b16 v[178:179], v246 offset:24424
    v_mfma_f32_16x16x32_bf16 v[68:71], v[112:115], v[104:107], 0
    v_mfma_f32_16x16x32_bf16 v[72:75], v[116:119], v[104:107], 0
    s_add_u32 m0, s49, 57344
    s_movk_i32 s46, 256
    buffer_load_dwordx4 v185, s[24:27], s46 offen lds
    ds_read_b64_tr_b16 v[222:223], v226 offset:2048
    v_mfma_f32_16x16x32_bf16 v[76:79], v[120:123], v[104:107], 0
    v_mfma_f32_16x16x32_bf16 v[80:83], v[124:127], v[104:107], 0
    v_mfma_f32_16x16x32_bf16 v[84:87], v[104:107], v[128:131], 0
    s_mov_b32 s68, s40
    s_add_u32 s46, s68, 3
    s_mul_i32 s46, s46, 245760
    s_cmp_lt_u32 s68, 2
    s_cselect_b32 s46, s46, 2457600
    buffer_load_dword v191, v189, s[28:31], s46 offen
    v_mfma_f32_16x16x32_bf16 v[88:91], v[104:107], v[132:135], 0
    s_waitcnt vmcnt(5) lgkmcnt(0)
    s_barrier
    s_cmp_lt_u32 s40, 4
    s_cbranch_scc0 SK_27
    v_mfma_f32_16x16x32_bf16 v[28:31], v[140:143], v[180:183], v[28:31]
    ds_read_b64_tr_b16 v[136:137], v248 offset:32768
    v_mfma_f32_16x16x32_bf16 v[60:63], v[144:147], v[180:183], v[60:63]
    ds_read_b64_tr_b16 v[138:139], v248 offset:40448
    v_mfma_f32_16x16x32_bf16 v[92:95], v[148:151], v[180:183], v[92:95]
SK_27:
    v_mfma_f32_16x16x32_bf16 v[0:3], v[152:155], v[140:143], v[0:3]
    ds_read_b64_tr_b16 v[108:109], v246 offset:32768
    ds_read_b64_tr_b16 v[110:111], v246 offset:40448
    v_mfma_f32_16x16x32_bf16 v[4:7], v[156:159], v[140:143], v[4:7]
    ds_read_b64_tr_b16 v[112:113], v246 offset:32808
    v_mfma_f32_16x16x32_bf16 v[8:11], v[160:163], v[140:143], v[8:11]
    s_add_u32 m0, s47, 65536
    s_mul_i32 s44, s45, 4
    buffer_load_dwordx4 v187, s[28:31], s44 offen lds
    ds_read_b128 v[96:99], v244 offset:24576
    v_mfma_f32_16x16x32_bf16 v[12:15], v[164:167], v[140:143], v[12:15]
    ds_read_b64_tr_b16 v[114:115], v246 offset:40488
    v_mfma_f32_16x16x32_bf16 v[16:19], v[168:171], v[140:143], v[16:19]
    ds_read_b64_tr_b16 v[116:117], v246 offset:32928
    v_mfma_f32_16x16x32_bf16 v[20:23], v[140:143], v[172:175], v[20:23]
    s_cmp_lt_u32 s76, 3031040
    s_cbranch_scc0 SK_16
    buffer_store_dwordx4 v[216:219], v254, s[52:55], s76 offen sc1
    buffer_store_dwordx4 v[220:223], v254, s[52:55], s77 offen sc1
SK_16:
    ds_read_b64_tr_b16 v[118:119], v246 offset:40608
    v_mfma_f32_16x16x32_bf16 v[24:27], v[140:143], v[176:179], v[24:27]
    ds_read_b64_tr_b16 v[120:121], v246 offset:32968
    v_mfma_f32_16x16x32_bf16 v[56:59], v[144:147], v[176:179], v[56:59]
    s_add_u32 m0, s48, 65536
    s_mul_i32 s44, s45, 4
    buffer_load_dwordx4 v188, s[28:31], s44 offen lds
    ds_read_b64_tr_b16 v[122:123], v246 offset:40648
    v_mfma_f32_16x16x32_bf16 v[52:55], v[144:147], v[172:175], v[52:55]
    ds_read_b128 v[100:103], v244 offset:26624
    v_mfma_f32_16x16x32_bf16 v[48:51], v[168:171], v[144:147], v[48:51]
    ds_read_b64_tr_b16 v[124:125], v247 offset:32768
    v_mfma_f32_16x16x32_bf16 v[44:47], v[164:167], v[144:147], v[44:47]
    ds_read_b64_tr_b16 v[126:127], v247 offset:40448
    ds_read_b64_tr_b16 v[128:129], v246 offset:33088
    v_mfma_f32_16x16x32_bf16 v[40:43], v[160:163], v[144:147], v[40:43]
    ds_read_b64_tr_b16 v[130:131], v246 offset:40768
    v_mfma_f32_16x16x32_bf16 v[36:39], v[156:159], v[144:147], v[36:39]
    s_add_u32 m0, s49, 65536
    s_movk_i32 s46, 256
    buffer_load_dwordx4 v186, s[24:27], s46 offen lds
    ds_read_b64_tr_b16 v[132:133], v246 offset:33128
    v_mfma_f32_16x16x32_bf16 v[32:35], v[152:155], v[144:147], v[32:35]
    ds_read_b128 v[104:107], v244 offset:28672
    v_mfma_f32_16x16x32_bf16 v[64:67], v[152:155], v[148:151], v[64:67]
    ds_read_b64_tr_b16 v[134:135], v246 offset:40808
    v_mfma_f32_16x16x32_bf16 v[68:71], v[156:159], v[148:151], v[68:71]
    s_mov_b64 exec, 1
    buffer_store_dwordx4 v[212:215], off, s[32:35], s96 sc1
    s_mov_b64 exec, -1
    v_mfma_f32_16x16x32_bf16 v[72:75], v[160:163], v[148:151], v[72:75]
    v_mfma_f32_16x16x32_bf16 v[76:79], v[164:167], v[148:151], v[76:79]
    s_add_u32 m0, s47, 0
    s_mul_i32 s44, s45, 5
    buffer_load_dwordx4 v187, s[28:31], s44 offen lds
    v_mfma_f32_16x16x32_bf16 v[80:83], v[168:171], v[148:151], v[80:83]
    v_mfma_f32_16x16x32_bf16 v[84:87], v[148:151], v[172:175], v[84:87]
    v_mfma_f32_16x16x32_bf16 v[88:91], v[148:151], v[176:179], v[88:91]
    s_waitcnt vmcnt(8) lgkmcnt(0)
    s_barrier
    v_add_u32 v246, 49152, v246
    v_add_u32 v247, 49152, v247
    v_add_u32 v248, 49152, v248
    s_cmp_lt_u32 s40, 4
    s_cbranch_scc0 SK_28
    v_mfma_f32_16x16x32_bf16 v[28:31], v[96:99], v[136:139], v[28:31]
    ds_read_b64_tr_b16 v[180:181], v248 offset:0
    v_mfma_f32_16x16x32_bf16 v[60:63], v[100:103], v[136:139], v[60:63]
    ds_read_b64_tr_b16 v[182:183], v248 offset:7680
    v_mfma_f32_16x16x32_bf16 v[92:95], v[104:107], v[136:139], v[92:95]
SK_28:
    v_mfma_f32_16x16x32_bf16 v[0:3], v[108:111], v[96:99], v[0:3]
    ds_read_b64_tr_b16 v[152:153], v246 offset:0
    ds_read_b64_tr_b16 v[154:155], v246 offset:7680
    v_mfma_f32_16x16x32_bf16 v[4:7], v[112:115], v[96:99], v[4:7]
    ds_read_b64_tr_b16 v[156:157], v246 offset:40
    v_mfma_f32_16x16x32_bf16 v[8:11], v[116:119], v[96:99], v[8:11]
    s_add_u32 m0, s48, 0
    s_mul_i32 s44, s45, 5
    buffer_load_dwordx4 v188, s[28:31], s44 offen lds
    v_mfma_f32_16x16x32_bf16 v[12:15], v[120:123], v[96:99], v[12:15]
    ds_read_b128 v[140:143], v245 offset:24576
    ds_read_b64_tr_b16 v[158:159], v246 offset:7720
    v_mfma_f32_16x16x32_bf16 v[16:19], v[124:127], v[96:99], v[16:19]
    ds_read_b64_tr_b16 v[160:161], v246 offset:160
    v_mfma_f32_16x16x32_bf16 v[20:23], v[96:99], v[128:131], v[20:23]
    ds_read_b64_tr_b16 v[162:163], v246 offset:7840
    v_mfma_f32_16x16x32_bf16 v[24:27], v[96:99], v[132:135], v[24:27]
    ds_read_b64_tr_b16 v[164:165], v246 offset:200
    s_add_u32 m0, s47, 16384
    s_mul_i32 s44, s45, 6
    buffer_load_dwordx4 v187, s[28:31], s44 offen lds
    v_mfma_f32_16x16x32_bf16 v[56:59], v[100:103], v[132:135], v[56:59]
    ds_read_b64_tr_b16 v[166:167], v246 offset:7880
    v_mfma_f32_16x16x32_bf16 v[52:55], v[100:103], v[128:131], v[52:55]
    ds_read_b128 v[144:147], v245 offset:26624
    v_mfma_f32_16x16x32_bf16 v[48:51], v[124:127], v[100:103], v[48:51]
    ds_read_b64_tr_b16 v[168:169], v247 offset:0
    v_mfma_f32_16x16x32_bf16 v[44:47], v[120:123], v[100:103], v[44:47]
    ds_read_b64_tr_b16 v[170:171], v247 offset:7680
    ds_read_b64_tr_b16 v[172:173], v246 offset:320
    v_mfma_f32_16x16x32_bf16 v[40:43], v[116:119], v[100:103], v[40:43]
    ds_read_b64_tr_b16 v[174:175], v246 offset:8000
    v_mfma_f32_16x16x32_bf16 v[36:39], v[112:115], v[100:103], v[36:39]
    s_add_u32 m0, s48, 16384
    s_mul_i32 s44, s45, 6
    buffer_load_dwordx4 v188, s[28:31], s44 offen lds
    v_mfma_f32_16x16x32_bf16 v[32:35], v[108:111], v[100:103], v[32:35]
    ds_read_b64_tr_b16 v[176:177], v246 offset:360
    ds_read_b128 v[148:151], v245 offset:28672
    v_mfma_f32_16x16x32_bf16 v[64:67], v[108:111], v[104:107], v[64:67]
    ds_read_b64_tr_b16 v[178:179], v246 offset:8040
    v_mfma_f32_16x16x32_bf16 v[68:71], v[112:115], v[104:107], v[68:71]
    v_mfma_f32_16x16x32_bf16 v[72:75], v[116:119], v[104:107], v[72:75]
    s_add_u32 m0, s49, 0
    s_movk_i32 s46, 384
    s_mov_b64 exec, s[56:57]
    buffer_load_dwordx4 v184, s[24:27], s46 offen lds
    s_mov_b64 exec, -1
    v_mfma_f32_16x16x32_bf16 v[76:79], v[120:123], v[104:107], v[76:79]
    v_mfma_f32_16x16x32_bf16 v[80:83], v[124:127], v[104:107], v[80:83]
    v_mfma_f32_16x16x32_bf16 v[84:87], v[104:107], v[128:131], v[84:87]
    v_mfma_f32_16x16x32_bf16 v[88:91], v[104:107], v[132:135], v[88:91]
    s_waitcnt vmcnt(6) lgkmcnt(0)
    s_barrier
    s_cmp_lt_u32 s40, 4
    s_cbranch_scc0 SK_29
    v_mfma_f32_16x16x32_bf16 v[28:31], v[140:143], v[180:183], v[28:31]
    ds_read_b64_tr_b16 v[136:137], v248 offset:16384
    v_mfma_f32_16x16x32_bf16 v[60:63], v[144:147], v[180:183], v[60:63]
    ds_read_b64_tr_b16 v[138:139], v248 offset:24064
    v_mfma_f32_16x16x32_bf16 v[92:95], v[148:151], v[180:183], v[92:95]
SK_29:
    v_mfma_f32_16x16x32_bf16 v[0:3], v[152:155], v[140:143], v[0:3]
    ds_read_b64_tr_b16 v[108:109], v246 offset:16384
    ds_read_b64_tr_b16 v[110:111], v246 offset:24064
    v_mfma_f32_16x16x32_bf16 v[4:7], v[156:159], v[140:143], v[4:7]
    ds_read_b64_tr_b16 v[112:113], v246 offset:16424
    v_mfma_f32_16x16x32_bf16 v[8:11], v[160:163], v[140:143], v[8:11]
    s_add_u32 m0, s49, 8192
    s_movk_i32 s46, 384
    buffer_load_dwordx4 v185, s[24:27], s46 offen lds
    v_mfma_f32_16x16x32_bf16 v[12:15], v[164:167], v[140:143], v[12:15]
    ds_read_b128 v[96:99], v244 offset:49152
    ds_read_b64_tr_b16 v[114:115], v246 offset:24104
    v_mfma_f32_16x16x32_bf16 v[16:19], v[168:171], v[140:143], v[16:19]
    ds_read_b64_tr_b16 v[116:117], v246 offset:16544
    v_mfma_f32_16x16x32_bf16 v[20:23], v[140:143], v[172:175], v[20:23]
    ds_read_b64_tr_b16 v[118:119], v246 offset:24224
    v_mfma_f32_16x16x32_bf16 v[24:27], v[140:143], v[176:179], v[24:27]
    ds_read_b64_tr_b16 v[120:121], v246 offset:16584
    s_add_u32 m0, s49, 16384
    s_movk_i32 s46, 384
    buffer_load_dwordx4 v186, s[24:27], s46 offen lds
    v_mfma_f32_16x16x32_bf16 v[56:59], v[144:147], v[176:179], v[56:59]
    ds_read_b64_tr_b16 v[122:123], v246 offset:24264
    v_mfma_f32_16x16x32_bf16 v[52:55], v[144:147], v[172:175], v[52:55]
    ds_read_b128 v[100:103], v244 offset:51200
    v_mfma_f32_16x16x32_bf16 v[48:51], v[168:171], v[144:147], v[48:51]
    ds_read_b64_tr_b16 v[124:125], v247 offset:16384
    v_mfma_f32_16x16x32_bf16 v[44:47], v[164:167], v[144:147], v[44:47]
    ds_read_b64_tr_b16 v[126:127], v247 offset:24064
    ds_read_b64_tr_b16 v[128:129], v246 offset:16704
    v_mfma_f32_16x16x32_bf16 v[40:43], v[160:163], v[144:147], v[40:43]
    ds_read_b64_tr_b16 v[130:131], v246 offset:24384
    v_mfma_f32_16x16x32_bf16 v[36:39], v[156:159], v[144:147], v[36:39]
    s_add_u32 m0, s47, 32768
    s_mul_i32 s44, s45, 7
    buffer_load_dwordx4 v187, s[28:31], s44 offen lds
    v_mfma_f32_16x16x32_bf16 v[32:35], v[152:155], v[144:147], v[32:35]
    ds_read_b64_tr_b16 v[132:133], v246 offset:16744
    ds_read_b128 v[104:107], v244 offset:53248
    v_mfma_f32_16x16x32_bf16 v[64:67], v[152:155], v[148:151], v[64:67]
    ds_read_b64_tr_b16 v[134:135], v246 offset:24424
    v_mfma_f32_16x16x32_bf16 v[68:71], v[156:159], v[148:151], v[68:71]
    v_mfma_f32_16x16x32_bf16 v[72:75], v[160:163], v[148:151], v[72:75]
    s_add_u32 m0, s48, 32768
    s_mul_i32 s44, s45, 7
    buffer_load_dwordx4 v188, s[28:31], s44 offen lds
    v_mfma_f32_16x16x32_bf16 v[76:79], v[164:167], v[148:151], v[76:79]
    v_mfma_f32_16x16x32_bf16 v[80:83], v[168:171], v[148:151], v[80:83]
    v_mfma_f32_16x16x32_bf16 v[84:87], v[148:151], v[172:175], v[84:87]
    v_mfma_f32_16x16x32_bf16 v[88:91], v[148:151], v[176:179], v[88:91]
    s_waitcnt vmcnt(7) lgkmcnt(0)
    s_barrier
    v_subrev_u32 v246, 49152, v246
    v_subrev_u32 v247, 49152, v247
    v_subrev_u32 v248, 49152, v248
    s_cmp_lt_u32 s40, 4
    s_cbranch_scc0 SK_30
    v_mfma_f32_16x16x32_bf16 v[28:31], v[96:99], v[136:139], v[28:31]
    ds_read_b64_tr_b16 v[180:181], v248 offset:0
    v_mfma_f32_16x16x32_bf16 v[60:63], v[100:103], v[136:139], v[60:63]
    ds_read_b64_tr_b16 v[182:183], v248 offset:7680
    v_mfma_f32_16x16x32_bf16 v[92:95], v[104:107], v[136:139], v[92:95]
SK_30:
    v_mfma_f32_16x16x32_bf16 v[0:3], v[108:111], v[96:99], v[0:3]
    ds_read_b64_tr_b16 v[152:153], v246 offset:0
    ds_read_b64_tr_b16 v[154:155], v246 offset:7680
    v_mfma_f32_16x16x32_bf16 v[4:7], v[112:115], v[96:99], v[4:7]
    ds_read_b64_tr_b16 v[156:157], v246 offset:40
    v_mfma_f32_16x16x32_bf16 v[8:11], v[116:119], v[96:99], v[8:11]
    s_add_u32 m0, s47, 49152
    s_mul_i32 s44, s45, 8
    buffer_load_dwordx4 v187, s[28:31], s44 offen lds
    ds_read_b128 v[140:143], v245 offset:49152
    v_mfma_f32_16x16x32_bf16 v[12:15], v[120:123], v[96:99], v[12:15]
    ds_read_b64_tr_b16 v[158:159], v246 offset:7720
    v_mfma_f32_16x16x32_bf16 v[16:19], v[124:127], v[96:99], v[16:19]
    ds_read_b64_tr_b16 v[160:161], v246 offset:160
    v_mfma_f32_16x16x32_bf16 v[20:23], v[96:99], v[128:131], v[20:23]
    ds_read_b64_tr_b16 v[162:163], v246 offset:7840
    ds_read_b64_tr_b16 v[164:165], v246 offset:200
    v_mfma_f32_16x16x32_bf16 v[24:27], v[96:99], v[132:135], v[24:27]
    s_add_u32 m0, s48, 49152
    s_mul_i32 s44, s45, 8
    buffer_load_dwordx4 v188, s[28:31], s44 offen lds
    v_mfma_f32_16x16x32_bf16 v[56:59], v[100:103], v[132:135], v[56:59]
    ds_read_b64_tr_b16 v[166:167], v246 offset:7880
    ds_read_b128 v[144:147], v245 offset:51200
    v_mfma_f32_16x16x32_bf16 v[52:55], v[100:103], v[128:131], v[52:55]
    ds_read_b64_tr_b16 v[168:169], v247 offset:0
    v_mfma_f32_16x16x32_bf16 v[48:51], v[124:127], v[100:103], v[48:51]
    s_cmp_eq_u32 s40, 0
    s_cbranch_scc0 SK_21
    s_and_b32 s68, s2, 15
    s_lshl_b32 s68, s68, 4
    v_mov_b32 v252, 1
    s_mov_b64 exec, 1
    buffer_atomic_add v252, off, s[64:67], s68 sc1
    s_mov_b64 exec, -1
SK_21:
    v_mfma_f32_16x16x32_bf16 v[44:47], v[120:123], v[100:103], v[44:47]
    ds_read_b64_tr_b16 v[170:171], v247 offset:7680
    ds_read_b64_tr_b16 v[172:173], v246 offset:320
    v_mfma_f32_16x16x32_bf16 v[40:43], v[116:119], v[100:103], v[40:43]
    ds_read_b64_tr_b16 v[174:175], v246 offset:8000
    v_mfma_f32_16x16x32_bf16 v[36:39], v[112:115], v[100:103], v[36:39]
    s_add_u32 m0, s49, 24576
    s_movk_i32 s46, 512
    s_mov_b64 exec, s[56:57]
    buffer_load_dwordx4 v184, s[24:27], s46 offen lds
    s_mov_b64 exec, -1
    ds_read_b64_tr_b16 v[176:177], v246 offset:360
    v_mfma_f32_16x16x32_bf16 v[32:35], v[108:111], v[100:103], v[32:35]
    ds_read_b128 v[148:151], v245 offset:53248
    v_mfma_f32_16x16x32_bf16 v[64:67], v[108:111], v[104:107], v[64:67]
    ds_read_b64_tr_b16 v[178:179], v246 offset:8040
    v_mfma_f32_16x16x32_bf16 v[68:71], v[112:115], v[104:107], v[68:71]
    v_mfma_f32_16x16x32_bf16 v[72:75], v[116:119], v[104:107], v[72:75]
    s_add_u32 m0, s49, 32768
    s_movk_i32 s46, 512
    buffer_load_dwordx4 v185, s[24:27], s46 offen lds
    v_mfma_f32_16x16x32_bf16 v[76:79], v[120:123], v[104:107], v[76:79]
    v_mfma_f32_16x16x32_bf16 v[80:83], v[124:127], v[104:107], v[80:83]
    v_mfma_f32_16x16x32_bf16 v[84:87], v[104:107], v[128:131], v[84:87]
    s_mov_b32 s68, s40
    s_add_u32 s46, s68, 5
    s_mul_i32 s46, s46, 245760
    s_cmp_lt_u32 s68, 2
    s_cselect_b32 s46, s46, 2457600
    buffer_load_dword v191, v189, s[28:31], s46 offen
    v_mfma_f32_16x16x32_bf16 v[88:91], v[104:107], v[132:135], v[88:91]
    s_waitcnt vmcnt(7) lgkmcnt(0)
    s_barrier
    s_cmp_lt_u32 s40, 4
    s_cbranch_scc0 SK_31
    v_mfma_f32_16x16x32_bf16 v[28:31], v[140:143], v[180:183], v[28:31]
    ds_read_b64_tr_b16 v[136:137], v248 offset:16384
    v_mfma_f32_16x16x32_bf16 v[60:63], v[144:147], v[180:183], v[60:63]
    ds_read_b64_tr_b16 v[138:139], v248 offset:24064
    v_mfma_f32_16x16x32_bf16 v[92:95], v[148:151], v[180:183], v[92:95]
SK_31:
    v_mfma_f32_16x16x32_bf16 v[0:3], v[152:155], v[140:143], v[0:3]
    ds_read_b64_tr_b16 v[108:109], v246 offset:16384
    ds_read_b64_tr_b16 v[110:111], v246 offset:24064
    v_mfma_f32_16x16x32_bf16 v[4:7], v[156:159], v[140:143], v[4:7]
    ds_read_b64_tr_b16 v[112:113], v246 offset:16424
    v_mfma_f32_16x16x32_bf16 v[8:11], v[160:163], v[140:143], v[8:11]
    s_add_u32 m0, s49, 40960
    s_movk_i32 s46, 512
    buffer_load_dwordx4 v186, s[24:27], s46 offen lds
    v_mfma_f32_16x16x32_bf16 v[12:15], v[164:167], v[140:143], v[12:15]
    ds_read_b128 v[96:99], v244 offset:0
    ds_read_b64_tr_b16 v[114:115], v246 offset:24104
    v_mfma_f32_16x16x32_bf16 v[16:19], v[168:171], v[140:143], v[16:19]
    ds_read_b64_tr_b16 v[116:117], v246 offset:16544
    v_mfma_f32_16x16x32_bf16 v[20:23], v[140:143], v[172:175], v[20:23]
    ds_read_b64_tr_b16 v[118:119], v246 offset:24224
    v_mfma_f32_16x16x32_bf16 v[24:27], v[140:143], v[176:179], v[24:27]
    ds_read_b64_tr_b16 v[120:121], v246 offset:16584
    s_add_u32 m0, s47, 65536
    s_mul_i32 s44, s45, 9
    buffer_load_dwordx4 v187, s[28:31], s44 offen lds
    v_mfma_f32_16x16x32_bf16 v[56:59], v[144:147], v[176:179], v[56:59]
    ds_read_b64_tr_b16 v[122:123], v246 offset:24264
    v_mfma_f32_16x16x32_bf16 v[52:55], v[144:147], v[172:175], v[52:55]
    ds_read_b128 v[100:103], v244 offset:2048
    v_mfma_f32_16x16x32_bf16 v[48:51], v[168:171], v[144:147], v[48:51]
    ds_read_b64_tr_b16 v[124:125], v247 offset:16384
    v_mfma_f32_16x16x32_bf16 v[44:47], v[164:167], v[144:147], v[44:47]
    ds_read_b64_tr_b16 v[126:127], v247 offset:24064
    ds_read_b64_tr_b16 v[128:129], v246 offset:16704
    v_mfma_f32_16x16x32_bf16 v[40:43], v[160:163], v[144:147], v[40:43]
    ds_read_b64_tr_b16 v[130:131], v246 offset:24384
    v_mfma_f32_16x16x32_bf16 v[36:39], v[156:159], v[144:147], v[36:39]
    s_add_u32 m0, s48, 65536
    s_mul_i32 s44, s45, 9
    buffer_load_dwordx4 v188, s[28:31], s44 offen lds
    v_mfma_f32_16x16x32_bf16 v[32:35], v[152:155], v[144:147], v[32:35]
    ds_read_b64_tr_b16 v[132:133], v246 offset:16744
    ds_read_b128 v[104:107], v244 offset:4096
    v_mfma_f32_16x16x32_bf16 v[64:67], v[152:155], v[148:151], v[64:67]
    ds_read_b64_tr_b16 v[134:135], v246 offset:24424
    v_mfma_f32_16x16x32_bf16 v[68:71], v[156:159], v[148:151], v[68:71]
    v_mfma_f32_16x16x32_bf16 v[72:75], v[160:163], v[148:151], v[72:75]
    s_add_u32 m0, s47, 0
    s_mul_i32 s44, s45, 10
    buffer_load_dwordx4 v187, s[28:31], s44 offen lds
    v_mfma_f32_16x16x32_bf16 v[76:79], v[164:167], v[148:151], v[76:79]
    v_mfma_f32_16x16x32_bf16 v[80:83], v[168:171], v[148:151], v[80:83]
    v_mfma_f32_16x16x32_bf16 v[84:87], v[148:151], v[172:175], v[84:87]
    v_mfma_f32_16x16x32_bf16 v[88:91], v[148:151], v[176:179], v[88:91]
    s_waitcnt vmcnt(9) lgkmcnt(0)
    s_barrier
    s_cmp_lt_u32 s40, 4
    s_cbranch_scc0 SK_32
    v_mfma_f32_16x16x32_bf16 v[28:31], v[96:99], v[136:139], v[28:31]
    ds_read_b64_tr_b16 v[180:181], v248 offset:32768
    v_mfma_f32_16x16x32_bf16 v[60:63], v[100:103], v[136:139], v[60:63]
    ds_read_b64_tr_b16 v[182:183], v248 offset:40448
    v_mfma_f32_16x16x32_bf16 v[92:95], v[104:107], v[136:139], v[92:95]
SK_32:
    v_mfma_f32_16x16x32_bf16 v[0:3], v[108:111], v[96:99], v[0:3]
    ds_read_b64_tr_b16 v[152:153], v246 offset:32768
    ds_read_b64_tr_b16 v[154:155], v246 offset:40448
    v_mfma_f32_16x16x32_bf16 v[4:7], v[112:115], v[96:99], v[4:7]
    ds_read_b64_tr_b16 v[156:157], v246 offset:32808
    v_mfma_f32_16x16x32_bf16 v[8:11], v[116:119], v[96:99], v[8:11]
    s_add_u32 m0, s48, 0
    s_mul_i32 s44, s45, 10
    buffer_load_dwordx4 v188, s[28:31], s44 offen lds
    v_mfma_f32_16x16x32_bf16 v[12:15], v[120:123], v[96:99], v[12:15]
    ds_read_b128 v[140:143], v245 offset:0
    ds_read_b64_tr_b16 v[158:159], v246 offset:40488
    v_mfma_f32_16x16x32_bf16 v[16:19], v[124:127], v[96:99], v[16:19]
    ds_read_b64_tr_b16 v[160:161], v246 offset:32928
    v_mfma_f32_16x16x32_bf16 v[20:23], v[96:99], v[128:131], v[20:23]
    ds_read_b64_tr_b16 v[162:163], v246 offset:40608
    v_mfma_f32_16x16x32_bf16 v[24:27], v[96:99], v[132:135], v[24:27]
    ds_read_b64_tr_b16 v[164:165], v246 offset:32968
    s_add_u32 m0, s49, 49152
    s_movk_i32 s46, 640
    s_mov_b64 exec, s[56:57]
    buffer_load_dwordx4 v184, s[24:27], s46 offen lds
    s_mov_b64 exec, -1
    v_mfma_f32_16x16x32_bf16 v[56:59], v[100:103], v[132:135], v[56:59]
    ds_read_b64_tr_b16 v[166:167], v246 offset:40648
    v_mfma_f32_16x16x32_bf16 v[52:55], v[100:103], v[128:131], v[52:55]
    ds_read_b128 v[144:147], v245 offset:2048
    v_mfma_f32_16x16x32_bf16 v[48:51], v[124:127], v[100:103], v[48:51]
    ds_read_b64_tr_b16 v[168:169], v247 offset:32768
    v_mfma_f32_16x16x32_bf16 v[44:47], v[120:123], v[100:103], v[44:47]
    ds_read_b64_tr_b16 v[170:171], v247 offset:40448
    ds_read_b64_tr_b16 v[172:173], v246 offset:33088
    v_mfma_f32_16x16x32_bf16 v[40:43], v[116:119], v[100:103], v[40:43]
    ds_read_b64_tr_b16 v[174:175], v246 offset:40768
    v_mfma_f32_16x16x32_bf16 v[36:39], v[112:115], v[100:103], v[36:39]
    s_add_u32 m0, s49, 57344
    s_movk_i32 s46, 640
    buffer_load_dwordx4 v185, s[24:27], s46 offen lds
    v_mfma_f32_16x16x32_bf16 v[32:35], v[108:111], v[100:103], v[32:35]
    ds_read_b64_tr_b16 v[176:177], v246 offset:33128
    ds_read_b128 v[148:151], v245 offset:4096
    v_mfma_f32_16x16x32_bf16 v[64:67], v[108:111], v[104:107], v[64:67]
    ds_read_b64_tr_b16 v[178:179], v246 offset:40808
    v_mfma_f32_16x16x32_bf16 v[68:71], v[112:115], v[104:107], v[68:71]
    v_mfma_f32_16x16x32_bf16 v[72:75], v[116:119], v[104:107], v[72:75]
    s_add_u32 m0, s49, 65536
    s_movk_i32 s46, 640
    buffer_load_dwordx4 v186, s[24:27], s46 offen lds
    v_mfma_f32_16x16x32_bf16 v[76:79], v[120:123], v[104:107], v[76:79]
    v_mfma_f32_16x16x32_bf16 v[80:83], v[124:127], v[104:107], v[80:83]
    v_mfma_f32_16x16x32_bf16 v[84:87], v[104:107], v[128:131], v[84:87]
    v_mfma_f32_16x16x32_bf16 v[88:91], v[104:107], v[132:135], v[88:91]
    s_waitcnt vmcnt(7) lgkmcnt(0)
    s_barrier
    v_add_u32 v246, 49152, v246
    v_add_u32 v247, 49152, v247
    v_add_u32 v248, 49152, v248
    s_cmp_lt_u32 s40, 4
    s_cbranch_scc0 SK_33
    v_mfma_f32_16x16x32_bf16 v[28:31], v[140:143], v[180:183], v[28:31]
    ds_read_b64_tr_b16 v[136:137], v248 offset:0
    v_mfma_f32_16x16x32_bf16 v[60:63], v[144:147], v[180:183], v[60:63]
    ds_read_b64_tr_b16 v[138:139], v248 offset:7680
    v_mfma_f32_16x16x32_bf16 v[92:95], v[148:151], v[180:183], v[92:95]
SK_33:
    v_mfma_f32_16x16x32_bf16 v[0:3], v[152:155], v[140:143], v[0:3]
    ds_read_b64_tr_b16 v[108:109], v246 offset:0
    ds_read_b64_tr_b16 v[110:111], v246 offset:7680
    v_mfma_f32_16x16x32_bf16 v[4:7], v[156:159], v[140:143], v[4:7]
    ds_read_b64_tr_b16 v[112:113], v246 offset:40
    v_mfma_f32_16x16x32_bf16 v[8:11], v[160:163], v[140:143], v[8:11]
    s_add_u32 m0, s47, 16384
    s_mul_i32 s44, s45, 11
    buffer_load_dwordx4 v187, s[28:31], s44 offen lds
    v_mfma_f32_16x16x32_bf16 v[12:15], v[164:167], v[140:143], v[12:15]
    ds_read_b128 v[96:99], v244 offset:24576
    ds_read_b64_tr_b16 v[114:115], v246 offset:7720
    v_mfma_f32_16x16x32_bf16 v[16:19], v[168:171], v[140:143], v[16:19]
    ds_read_b64_tr_b16 v[116:117], v246 offset:160
    v_mfma_f32_16x16x32_bf16 v[20:23], v[140:143], v[172:175], v[20:23]
    ds_read_b64_tr_b16 v[118:119], v246 offset:7840
    v_mfma_f32_16x16x32_bf16 v[24:27], v[140:143], v[176:179], v[24:27]
    ds_read_b64_tr_b16 v[120:121], v246 offset:200
    s_add_u32 m0, s48, 16384
    s_mul_i32 s44, s45, 11
    buffer_load_dwordx4 v188, s[28:31], s44 offen lds
    v_mfma_f32_16x16x32_bf16 v[56:59], v[144:147], v[176:179], v[56:59]
    ds_read_b64_tr_b16 v[122:123], v246 offset:7880
    v_mfma_f32_16x16x32_bf16 v[52:55], v[144:147], v[172:175], v[52:55]
    ds_read_b128 v[100:103], v244 offset:26624
    v_mfma_f32_16x16x32_bf16 v[48:51], v[168:171], v[144:147], v[48:51]
    ds_read_b64_tr_b16 v[124:125], v247 offset:0
    v_mfma_f32_16x16x32_bf16 v[44:47], v[164:167], v[144:147], v[44:47]
    ds_read_b64_tr_b16 v[126:127], v247 offset:7680
    ds_read_b64_tr_b16 v[128:129], v246 offset:320
    v_mfma_f32_16x16x32_bf16 v[40:43], v[160:163], v[144:147], v[40:43]
    ds_read_b64_tr_b16 v[130:131], v246 offset:8000
    v_mfma_f32_16x16x32_bf16 v[36:39], v[156:159], v[144:147], v[36:39]
    s_add_u32 m0, s47, 32768
    s_mul_i32 s44, s45, 12
    buffer_load_dwordx4 v187, s[28:31], s44 offen lds
    v_mfma_f32_16x16x32_bf16 v[32:35], v[152:155], v[144:147], v[32:35]
    ds_read_b64_tr_b16 v[132:133], v246 offset:360
    ds_read_b128 v[104:107], v244 offset:28672
    v_mfma_f32_16x16x32_bf16 v[64:67], v[152:155], v[148:151], v[64:67]
    ds_read_b64_tr_b16 v[134:135], v246 offset:8040
    v_mfma_f32_16x16x32_bf16 v[68:71], v[156:159], v[148:151], v[68:71]
    v_mfma_f32_16x16x32_bf16 v[72:75], v[160:163], v[148:151], v[72:75]
    s_add_u32 m0, s48, 32768
    s_mul_i32 s44, s45, 12
    buffer_load_dwordx4 v188, s[28:31], s44 offen lds
    v_mfma_f32_16x16x32_bf16 v[76:79], v[164:167], v[148:151], v[76:79]
    v_mfma_f32_16x16x32_bf16 v[80:83], v[168:171], v[148:151], v[80:83]
    v_mfma_f32_16x16x32_bf16 v[84:87], v[148:151], v[172:175], v[84:87]
    v_mfma_f32_16x16x32_bf16 v[88:91], v[148:151], v[176:179], v[88:91]
    s_waitcnt vmcnt(9) lgkmcnt(0)
    s_barrier
    s_cmp_lt_u32 s40, 4
    s_cbranch_scc0 SK_34
    v_mfma_f32_16x16x32_bf16 v[28:31], v[96:99], v[136:139], v[28:31]
    ds_read_b64_tr_b16 v[180:181], v248 offset:16384
    v_mfma_f32_16x16x32_bf16 v[60:63], v[100:103], v[136:139], v[60:63]
    ds_read_b64_tr_b16 v[182:183], v248 offset:24064
    v_mfma_f32_16x16x32_bf16 v[92:95], v[104:107], v[136:139], v[92:95]
SK_34:
    v_mfma_f32_16x16x32_bf16 v[0:3], v[108:111], v[96:99], v[0:3]
    ds_read_b64_tr_b16 v[152:153], v246 offset:16384
    ds_read_b64_tr_b16 v[154:155], v246 offset:24064
    v_mfma_f32_16x16x32_bf16 v[4:7], v[112:115], v[96:99], v[4:7]
    ds_read_b64_tr_b16 v[156:157], v246 offset:16424
    v_mfma_f32_16x16x32_bf16 v[8:11], v[116:119], v[96:99], v[8:11]
    s_add_u32 m0, s49, 0
    s_movk_i32 s46, 768
    s_mov_b64 exec, s[56:57]
    buffer_load_dwordx4 v184, s[24:27], s46 offen lds
    s_mov_b64 exec, -1
    ds_read_b128 v[140:143], v245 offset:24576
    v_mfma_f32_16x16x32_bf16 v[12:15], v[120:123], v[96:99], v[12:15]
    ds_read_b64_tr_b16 v[158:159], v246 offset:24104
    v_mfma_f32_16x16x32_bf16 v[16:19], v[124:127], v[96:99], v[16:19]
    ds_read_b64_tr_b16 v[160:161], v246 offset:16544
    v_mfma_f32_16x16x32_bf16 v[20:23], v[96:99], v[128:131], v[20:23]
    ds_read_b64_tr_b16 v[162:163], v246 offset:24224
    ds_read_b64_tr_b16 v[164:165], v246 offset:16584
    v_mfma_f32_16x16x32_bf16 v[24:27], v[96:99], v[132:135], v[24:27]
    s_add_u32 m0, s49, 8192
    s_movk_i32 s46, 768
    buffer_load_dwordx4 v185, s[24:27], s46 offen lds
    v_mfma_f32_16x16x32_bf16 v[56:59], v[100:103], v[132:135], v[56:59]
    ds_read_b64_tr_b16 v[166:167], v246 offset:24264
    v_mfma_f32_16x16x32_bf16 v[52:55], v[100:103], v[128:131], v[52:55]
    ds_read_b128 v[144:147], v245 offset:26624
    ds_read_b64_tr_b16 v[168:169], v247 offset:16384
    v_mfma_f32_16x16x32_bf16 v[48:51], v[124:127], v[100:103], v[48:51]
    ds_read_b64_tr_b16 v[170:171], v247 offset:24064
    v_mfma_f32_16x16x32_bf16 v[44:47], v[120:123], v[100:103], v[44:47]
    ds_read_b64_tr_b16 v[172:173], v246 offset:16704
    v_mfma_f32_16x16x32_bf16 v[40:43], v[116:119], v[100:103], v[40:43]
    ds_read_b64_tr_b16 v[174:175], v246 offset:24384
    s_add_u32 m0, s49, 16384
    s_movk_i32 s46, 768
    buffer_load_dwordx4 v186, s[24:27], s46 offen lds
    v_mfma_f32_16x16x32_bf16 v[36:39], v[112:115], v[100:103], v[36:39]
    ds_read_b64_tr_b16 v[176:177], v246 offset:16744
    v_mfma_f32_16x16x32_bf16 v[32:35], v[108:111], v[100:103], v[32:35]
    ds_read_b128 v[148:151], v245 offset:28672
    v_mfma_f32_16x16x32_bf16 v[64:67], v[108:111], v[104:107], v[64:67]
    ds_read_b64_tr_b16 v[178:179], v246 offset:24424
    v_mfma_f32_16x16x32_bf16 v[68:71], v[112:115], v[104:107], v[68:71]
    v_mfma_f32_16x16x32_bf16 v[72:75], v[116:119], v[104:107], v[72:75]
    s_add_u32 m0, s47, 49152
    s_mul_i32 s44, s45, 13
    buffer_load_dwordx4 v187, s[28:31], s44 offen lds
    v_mfma_f32_16x16x32_bf16 v[76:79], v[120:123], v[104:107], v[76:79]
    v_mfma_f32_16x16x32_bf16 v[80:83], v[124:127], v[104:107], v[80:83]
    v_mfma_f32_16x16x32_bf16 v[84:87], v[104:107], v[128:131], v[84:87]
    s_mov_b32 s68, s40
    s_add_u32 s46, s68, 7
    s_mul_i32 s46, s46, 245760
    s_cmp_lt_u32 s68, 2
    s_cselect_b32 s46, s46, 2457600
    buffer_load_dword v191, v189, s[28:31], s46 offen
    v_mfma_f32_16x16x32_bf16 v[88:91], v[104:107], v[132:135], v[88:91]
    s_waitcnt vmcnt(9) lgkmcnt(0)
    s_barrier
    v_subrev_u32 v246, 49152, v246
    v_subrev_u32 v247, 49152, v247
    v_subrev_u32 v248, 49152, v248
    s_cmp_lt_u32 s40, 4
    s_cbranch_scc0 SK_35
    v_mfma_f32_16x16x32_bf16 v[28:31], v[140:143], v[180:183], v[28:31]
    ds_read_b64_tr_b16 v[136:137], v248 offset:0
    v_mfma_f32_16x16x32_bf16 v[60:63], v[144:147], v[180:183], v[60:63]
    ds_read_b64_tr_b16 v[138:139], v248 offset:7680
    v_mfma_f32_16x16x32_bf16 v[92:95], v[148:151], v[180:183], v[92:95]
SK_35:
    v_mfma_f32_16x16x32_bf16 v[0:3], v[152:155], v[140:143], v[0:3]
    ds_read_b64_tr_b16 v[108:109], v246 offset:0
    ds_read_b64_tr_b16 v[110:111], v246 offset:7680
    v_mfma_f32_16x16x32_bf16 v[4:7], v[156:159], v[140:143], v[4:7]
    ds_read_b64_tr_b16 v[112:113], v246 offset:40
    v_mfma_f32_16x16x32_bf16 v[8:11], v[160:163], v[140:143], v[8:11]
    s_add_u32 m0, s48, 49152
    s_mul_i32 s44, s45, 13
    buffer_load_dwordx4 v188, s[28:31], s44 offen lds
    v_mfma_f32_16x16x32_bf16 v[12:15], v[164:167], v[140:143], v[12:15]
    ds_read_b128 v[96:99], v244 offset:49152
    ds_read_b64_tr_b16 v[114:115], v246 offset:7720
    v_mfma_f32_16x16x32_bf16 v[16:19], v[168:171], v[140:143], v[16:19]
    ds_read_b64_tr_b16 v[116:117], v246 offset:160
    v_mfma_f32_16x16x32_bf16 v[20:23], v[140:143], v[172:175], v[20:23]
    ds_read_b64_tr_b16 v[118:119], v246 offset:7840
    v_mfma_f32_16x16x32_bf16 v[24:27], v[140:143], v[176:179], v[24:27]
    ds_read_b64_tr_b16 v[120:121], v246 offset:200
    s_add_u32 m0, s47, 65536
    s_mul_i32 s44, s45, 14
    buffer_load_dwordx4 v187, s[28:31], s44 offen lds
    v_mfma_f32_16x16x32_bf16 v[56:59], v[144:147], v[176:179], v[56:59]
    ds_read_b64_tr_b16 v[122:123], v246 offset:7880
    v_mfma_f32_16x16x32_bf16 v[52:55], v[144:147], v[172:175], v[52:55]
    ds_read_b128 v[100:103], v244 offset:51200
    v_mfma_f32_16x16x32_bf16 v[48:51], v[168:171], v[144:147], v[48:51]
    ds_read_b64_tr_b16 v[124:125], v247 offset:0
    v_mfma_f32_16x16x32_bf16 v[44:47], v[164:167], v[144:147], v[44:47]
    ds_read_b64_tr_b16 v[126:127], v247 offset:7680
    ds_read_b64_tr_b16 v[128:129], v246 offset:320
    v_mfma_f32_16x16x32_bf16 v[40:43], v[160:163], v[144:147], v[40:43]
    ds_read_b64_tr_b16 v[130:131], v246 offset:8000
    v_mfma_f32_16x16x32_bf16 v[36:39], v[156:159], v[144:147], v[36:39]
    s_add_u32 m0, s48, 65536
    s_mul_i32 s44, s45, 14
    buffer_load_dwordx4 v188, s[28:31], s44 offen lds
    v_mfma_f32_16x16x32_bf16 v[32:35], v[152:155], v[144:147], v[32:35]
    ds_read_b64_tr_b16 v[132:133], v246 offset:360
    ds_read_b128 v[104:107], v244 offset:53248
    v_mfma_f32_16x16x32_bf16 v[64:67], v[152:155], v[148:151], v[64:67]
    ds_read_b64_tr_b16 v[134:135], v246 offset:8040
    v_mfma_f32_16x16x32_bf16 v[68:71], v[156:159], v[148:151], v[68:71]
    v_mfma_f32_16x16x32_bf16 v[72:75], v[160:163], v[148:151], v[72:75]
    s_add_u32 m0, s49, 24576
    s_movk_i32 s46, 896
    s_mov_b64 exec, s[56:57]
    buffer_load_dwordx4 v184, s[24:27], s46 offen lds
    s_mov_b64 exec, -1
    v_mfma_f32_16x16x32_bf16 v[76:79], v[164:167], v[148:151], v[76:79]
    v_mfma_f32_16x16x32_bf16 v[80:83], v[168:171], v[148:151], v[80:83]
    v_mfma_f32_16x16x32_bf16 v[84:87], v[148:151], v[172:175], v[84:87]
    v_mfma_f32_16x16x32_bf16 v[88:91], v[148:151], v[176:179], v[88:91]
    s_waitcnt vmcnt(11) lgkmcnt(0)
    s_barrier
    s_cmp_lt_u32 s40, 4
    s_cbranch_scc0 SK_36
    v_mfma_f32_16x16x32_bf16 v[28:31], v[96:99], v[136:139], v[28:31]
    ds_read_b64_tr_b16 v[180:181], v248 offset:16384
    v_mfma_f32_16x16x32_bf16 v[60:63], v[100:103], v[136:139], v[60:63]
    ds_read_b64_tr_b16 v[182:183], v248 offset:24064
    v_mfma_f32_16x16x32_bf16 v[92:95], v[104:107], v[136:139], v[92:95]
SK_36:
    v_mfma_f32_16x16x32_bf16 v[0:3], v[108:111], v[96:99], v[0:3]
    ds_read_b64_tr_b16 v[152:153], v246 offset:16384
    ds_read_b64_tr_b16 v[154:155], v246 offset:24064
    v_mfma_f32_16x16x32_bf16 v[4:7], v[112:115], v[96:99], v[4:7]
    ds_read_b64_tr_b16 v[156:157], v246 offset:16424
    v_mfma_f32_16x16x32_bf16 v[8:11], v[116:119], v[96:99], v[8:11]
    s_add_u32 m0, s49, 32768
    s_movk_i32 s46, 896
    buffer_load_dwordx4 v185, s[24:27], s46 offen lds
    ds_read_b128 v[140:143], v245 offset:49152
    v_mfma_f32_16x16x32_bf16 v[12:15], v[120:123], v[96:99], v[12:15]
    ds_read_b64_tr_b16 v[158:159], v246 offset:24104
    v_mfma_f32_16x16x32_bf16 v[16:19], v[124:127], v[96:99], v[16:19]
    ds_read_b64_tr_b16 v[160:161], v246 offset:16544
    v_mfma_f32_16x16x32_bf16 v[20:23], v[96:99], v[128:131], v[20:23]
    ds_read_b64_tr_b16 v[162:163], v246 offset:24224
    ds_read_b64_tr_b16 v[164:165], v246 offset:16584
    v_mfma_f32_16x16x32_bf16 v[24:27], v[96:99], v[132:135], v[24:27]
    s_add_u32 m0, s49, 40960
    s_movk_i32 s46, 896
    buffer_load_dwordx4 v186, s[24:27], s46 offen lds
    v_mfma_f32_16x16x32_bf16 v[56:59], v[100:103], v[132:135], v[56:59]
    ds_read_b64_tr_b16 v[166:167], v246 offset:24264
    v_mfma_f32_16x16x32_bf16 v[52:55], v[100:103], v[128:131], v[52:55]
    ds_read_b128 v[144:147], v245 offset:51200
    ds_read_b64_tr_b16 v[168:169], v247 offset:16384
    v_mfma_f32_16x16x32_bf16 v[48:51], v[124:127], v[100:103], v[48:51]
    s_cmp_eq_u32 s40, 0
    s_cbranch_scc0 SK_22
    v_and_b32 v253, 0xf0, v254
    buffer_load_dword v252, v253, s[64:67], 0 offen sc1
SK_22:
    v_mfma_f32_16x16x32_bf16 v[44:47], v[120:123], v[100:103], v[44:47]
    ds_read_b64_tr_b16 v[170:171], v247 offset:24064
    v_mfma_f32_16x16x32_bf16 v[40:43], v[116:119], v[100:103], v[40:43]
    ds_read_b64_tr_b16 v[172:173], v246 offset:16704
    ds_read_b64_tr_b16 v[174:175], v246 offset:24384
    v_mfma_f32_16x16x32_bf16 v[36:39], v[112:115], v[100:103], v[36:39]
    s_add_u32 m0, s47, 0
    s_mul_i32 s44, s45, 15
    buffer_load_dwordx4 v187, s[28:31], s44 offen lds
    v_mfma_f32_16x16x32_bf16 v[32:35], v[108:111], v[100:103], v[32:35]
    ds_read_b64_tr_b16 v[176:177], v246 offset:16744
    v_mfma_f32_16x16x32_bf16 v[64:67], v[108:111], v[104:107], v[64:67]
    ds_read_b128 v[148:151], v245 offset:53248
    ds_read_b64_tr_b16 v[178:179], v246 offset:24424
    v_mfma_f32_16x16x32_bf16 v[68:71], v[112:115], v[104:107], v[68:71]
    v_mfma_f32_16x16x32_bf16 v[72:75], v[116:119], v[104:107], v[72:75]
    v_mfma_f32_16x16x32_bf16 v[76:79], v[120:123], v[104:107], v[76:79]
    s_add_u32 m0, s48, 0
    s_mul_i32 s44, s45, 15
    buffer_load_dwordx4 v188, s[28:31], s44 offen lds
    v_mfma_f32_16x16x32_bf16 v[80:83], v[124:127], v[104:107], v[80:83]
    v_mfma_f32_16x16x32_bf16 v[84:87], v[104:107], v[128:131], v[84:87]
    v_mfma_f32_16x16x32_bf16 v[88:91], v[104:107], v[132:135], v[88:91]
    s_waitcnt vmcnt(10) lgkmcnt(0)
    s_cmp_lg_u32 s40, 0
    s_cbranch_scc1 CR_q_OK
    s_waitcnt vmcnt(2)
    s_mov_b32 s3, 0
CR_q_CHK:
    v_cmp_gt_u32 vcc, 16, v252
    s_nop 0
    s_cmp_eq_u64 vcc, 0
    s_cbranch_scc1 CR_q_OK
    s_add_u32 s3, s3, 1
    s_cmp_gt_u32 s3, 2097152
    s_cbranch_scc1 CR_q_OK
    s_sleep 24
    buffer_load_dword v252, v253, s[64:67], 0 offen sc1
    s_waitcnt vmcnt(0)
    s_branch CR_q_CHK
CR_q_OK:
    s_barrier
    s_cmp_lt_u32 s40, 4
    s_cbranch_scc0 SK_37
    v_mfma_f32_16x16x32_bf16 v[28:31], v[140:143], v[180:183], v[28:31]
    ds_read_b64_tr_b16 v[136:137], v248 offset:32768
    v_mfma_f32_16x16x32_bf16 v[60:63], v[144:147], v[180:183], v[60:63]
    ds_read_b64_tr_b16 v[138:139], v248 offset:40448
    v_mfma_f32_16x16x32_bf16 v[92:95], v[148:151], v[180:183], v[92:95]
SK_37:
    v_mfma_f32_16x16x32_bf16 v[0:3], v[152:155], v[140:143], v[0:3]
    ds_read_b64_tr_b16 v[108:109], v246 offset:32768
    ds_read_b64_tr_b16 v[110:111], v246 offset:40448
    v_mfma_f32_16x16x32_bf16 v[4:7], v[156:159], v[140:143], v[4:7]
    s_add_u32 m0, s47, 16384
    s_mul_i32 s44, s45, 16
    buffer_load_dwordx4 v187, s[28:31], s44 offen lds
    v_mfma_f32_16x16x32_bf16 v[8:11], v[160:163], v[140:143], v[8:11]
    ds_read_b64_tr_b16 v[112:113], v246 offset:32808
    ds_read_b128 v[96:99], v244 offset:0
    v_mfma_f32_16x16x32_bf16 v[12:15], v[164:167], v[140:143], v[12:15]
    ds_read_b64_tr_b16 v[114:115], v246 offset:40488
    v_mfma_f32_16x16x32_bf16 v[16:19], v[168:171], v[140:143], v[16:19]
    ds_read_b64_tr_b16 v[116:117], v246 offset:32928
    v_mfma_f32_16x16x32_bf16 v[20:23], v[140:143], v[172:175], v[20:23]
    ds_read_b64_tr_b16 v[118:119], v246 offset:40608
    s_add_u32 m0, s48, 16384
    s_mul_i32 s44, s45, 16
    buffer_load_dwordx4 v188, s[28:31], s44 offen lds
    v_mfma_f32_16x16x32_bf16 v[24:27], v[140:143], v[176:179], v[24:27]
    ds_read_b64_tr_b16 v[120:121], v246 offset:32968
    v_mfma_f32_16x16x32_bf16 v[56:59], v[144:147], v[176:179], v[56:59]
    ds_read_b64_tr_b16 v[122:123], v246 offset:40648
    ds_read_b128 v[100:103], v244 offset:2048
    v_mfma_f32_16x16x32_bf16 v[52:55], v[144:147], v[172:175], v[52:55]
    ds_read_b64_tr_b16 v[124:125], v247 offset:32768
    v_mfma_f32_16x16x32_bf16 v[48:51], v[168:171], v[144:147], v[48:51]
    s_add_u32 m0, s49, 49152
    s_movk_i32 s46, 1024
    s_mov_b64 exec, s[56:57]
    buffer_load_dwordx4 v184, s[24:27], s46 offen lds
    s_mov_b64 exec, -1
    v_mfma_f32_16x16x32_bf16 v[44:47], v[164:167], v[144:147], v[44:47]
    ds_read_b64_tr_b16 v[126:127], v247 offset:40448
    ds_read_b64_tr_b16 v[128:129], v246 offset:33088
    v_mfma_f32_16x16x32_bf16 v[40:43], v[160:163], v[144:147], v[40:43]
    ds_read_b64_tr_b16 v[130:131], v246 offset:40768
    v_mfma_f32_16x16x32_bf16 v[36:39], v[156:159], v[144:147], v[36:39]
    ds_read_b64_tr_b16 v[132:133], v246 offset:33128
    s_add_u32 m0, s49, 57344
    s_movk_i32 s46, 1024
    buffer_load_dwordx4 v185, s[24:27], s46 offen lds
    v_mfma_f32_16x16x32_bf16 v[32:35], v[152:155], v[144:147], v[32:35]
    ds_read_b128 v[104:107], v244 offset:4096
    v_mfma_f32_16x16x32_bf16 v[64:67], v[152:155], v[148:151], v[64:67]
    ds_read_b64_tr_b16 v[134:135], v246 offset:40808
    v_mfma_f32_16x16x32_bf16 v[68:71], v[156:159], v[148:151], v[68:71]
    v_mfma_f32_16x16x32_bf16 v[72:75], v[160:163], v[148:151], v[72:75]
    v_mfma_f32_16x16x32_bf16 v[76:79], v[164:167], v[148:151], v[76:79]
    s_add_u32 m0, s49, 65536
    s_movk_i32 s46, 1024
    buffer_load_dwordx4 v186, s[24:27], s46 offen lds
    v_mfma_f32_16x16x32_bf16 v[80:83], v[168:171], v[148:151], v[80:83]
    v_mfma_f32_16x16x32_bf16 v[84:87], v[148:151], v[172:175], v[84:87]
    s_mov_b32 s68, s40
    s_add_u32 s46, s68, 9
    s_mul_i32 s46, s46, 245760
    s_cmp_lt_u32 s68, 1
    s_cselect_b32 s46, s46, 2457600
    buffer_load_dword v191, v189, s[28:31], s46 offen
    v_mfma_f32_16x16x32_bf16 v[88:91], v[148:151], v[176:179], v[88:91]
    s_waitcnt vmcnt(13) lgkmcnt(0)
    s_barrier
    v_add_u32 v246, 49152, v246
    v_add_u32 v247, 49152, v247
    v_add_u32 v248, 49152, v248
    s_cmp_lt_u32 s40, 4
    s_cbranch_scc0 SK_38
    v_mfma_f32_16x16x32_bf16 v[28:31], v[96:99], v[136:139], v[28:31]
    ds_read_b64_tr_b16 v[180:181], v248 offset:0
    v_mfma_f32_16x16x32_bf16 v[60:63], v[100:103], v[136:139], v[60:63]
    ds_read_b64_tr_b16 v[182:183], v248 offset:7680
    v_mfma_f32_16x16x32_bf16 v[92:95], v[104:107], v[136:139], v[92:95]
SK_38:
    v_mfma_f32_16x16x32_bf16 v[0:3], v[108:111], v[96:99], v[0:3]
    ds_read_b64_tr_b16 v[152:153], v246 offset:0
    ds_read_b64_tr_b16 v[154:155], v246 offset:7680
    v_mfma_f32_16x16x32_bf16 v[4:7], v[112:115], v[96:99], v[4:7]
    s_add_u32 m0, s47, 32768
    s_mul_i32 s44, s45, 17
    buffer_load_dwordx4 v187, s[28:31], s44 offen lds
    v_mfma_f32_16x16x32_bf16 v[8:11], v[116:119], v[96:99], v[8:11]
    ds_read_b64_tr_b16 v[156:157], v246 offset:40
    ds_read_b128 v[140:143], v245 offset:0
    v_mfma_f32_16x16x32_bf16 v[12:15], v[120:123], v[96:99], v[12:15]
    ds_read_b64_tr_b16 v[158:159], v246 offset:7720
    v_mfma_f32_16x16x32_bf16 v[16:19], v[124:127], v[96:99], v[16:19]
    ds_read_b64_tr_b16 v[160:161], v246 offset:160
    v_mfma_f32_16x16x32_bf16 v[20:23], v[96:99], v[128:131], v[20:23]
    ds_read_b64_tr_b16 v[162:163], v246 offset:7840
    s_add_u32 m0, s48, 32768
    s_mul_i32 s44, s45, 17
    buffer_load_dwordx4 v188, s[28:31], s44 offen lds
    v_mfma_f32_16x16x32_bf16 v[24:27], v[96:99], v[132:135], v[24:27]
    ds_read_b64_tr_b16 v[164:165], v246 offset:200
    v_mfma_f32_16x16x32_bf16 v[56:59], v[100:103], v[132:135], v[56:59]
    ds_read_b64_tr_b16 v[166:167], v246 offset:7880
    v_mfma_f32_16x16x32_bf16 v[52:55], v[100:103], v[128:131], v[52:55]
    ds_read_b128 v[144:147], v245 offset:2048
    ds_read_b64_tr_b16 v[168:169], v247 offset:0
    v_mfma_f32_16x16x32_bf16 v[48:51], v[124:127], v[100:103], v[48:51]
    s_add_u32 s88, s92, 1
    s_add_u32 s88, s88, s94
    s_mul_i32 s88, s88, 5120
    s_add_u32 s89, s88, 4096
    buffer_load_dwordx4 v[204:207], v254, s[52:55], s88 offen offset:0 sc1
    v_mfma_f32_16x16x32_bf16 v[44:47], v[120:123], v[100:103], v[44:47]
    ds_read_b64_tr_b16 v[170:171], v247 offset:7680
    v_mfma_f32_16x16x32_bf16 v[40:43], v[116:119], v[100:103], v[40:43]
    ds_read_b64_tr_b16 v[172:173], v246 offset:320
    ds_read_b64_tr_b16 v[174:175], v246 offset:8000
    v_mfma_f32_16x16x32_bf16 v[36:39], v[112:115], v[100:103], v[36:39]
    ds_read_b64_tr_b16 v[176:177], v246 offset:360
    v_mfma_f32_16x16x32_bf16 v[32:35], v[108:111], v[100:103], v[32:35]
    buffer_load_dwordx4 v[208:211], v254, s[52:55], s88 offen offset:1024 sc1
    v_mfma_f32_16x16x32_bf16 v[64:67], v[108:111], v[104:107], v[64:67]
    ds_read_b128 v[148:151], v245 offset:4096
    ds_read_b64_tr_b16 v[178:179], v246 offset:8040
    v_mfma_f32_16x16x32_bf16 v[68:71], v[112:115], v[104:107], v[68:71]
    v_mfma_f32_16x16x32_bf16 v[72:75], v[116:119], v[104:107], v[72:75]
    v_mfma_f32_16x16x32_bf16 v[76:79], v[120:123], v[104:107], v[76:79]
    buffer_load_dwordx4 v[212:215], v254, s[52:55], s88 offen offset:2048 sc1
    v_mfma_f32_16x16x32_bf16 v[80:83], v[124:127], v[104:107], v[80:83]
    v_mfma_f32_16x16x32_bf16 v[84:87], v[104:107], v[128:131], v[84:87]
    v_mfma_f32_16x16x32_bf16 v[88:91], v[104:107], v[132:135], v[88:91]
    s_waitcnt vmcnt(13) lgkmcnt(0)
    s_barrier
    s_cmp_lt_u32 s40, 4
    s_cbranch_scc0 SK_39
    v_mfma_f32_16x16x32_bf16 v[28:31], v[140:143], v[180:183], v[28:31]
    ds_read_b64_tr_b16 v[136:137], v248 offset:16384
    v_mfma_f32_16x16x32_bf16 v[60:63], v[144:147], v[180:183], v[60:63]
    ds_read_b64_tr_b16 v[138:139], v248 offset:24064
    v_mfma_f32_16x16x32_bf16 v[92:95], v[148:151], v[180:183], v[92:95]
SK_39:
    v_mfma_f32_16x16x32_bf16 v[0:3], v[152:155], v[140:143], v[0:3]
    ds_read_b64_tr_b16 v[108:109], v246 offset:16384
    ds_read_b64_tr_b16 v[110:111], v246 offset:24064
    v_mfma_f32_16x16x32_bf16 v[4:7], v[156:159], v[140:143], v[4:7]
    s_add_u32 m0, s47, 49152
    s_mul_i32 s44, s45, 18
    buffer_load_dwordx4 v187, s[28:31], s44 offen lds
    v_mfma_f32_16x16x32_bf16 v[8:11], v[160:163], v[140:143], v[8:11]
    ds_read_b64_tr_b16 v[112:113], v246 offset:16424
    ds_read_b128 v[96:99], v244 offset:24576
    v_mfma_f32_16x16x32_bf16 v[12:15], v[164:167], v[140:143], v[12:15]
    ds_read_b64_tr_b16 v[114:115], v246 offset:24104
    v_mfma_f32_16x16x32_bf16 v[16:19], v[168:171], v[140:143], v[16:19]
    ds_read_b64_tr_b16 v[116:117], v246 offset:16544
    v_mfma_f32_16x16x32_bf16 v[20:23], v[140:143], v[172:175], v[20:23]
    ds_read_b64_tr_b16 v[118:119], v246 offset:24224
    s_add_u32 m0, s48, 49152
    s_mul_i32 s44, s45, 18
    buffer_load_dwordx4 v188, s[28:31], s44 offen lds
    v_mfma_f32_16x16x32_bf16 v[24:27], v[140:143], v[176:179], v[24:27]
    ds_read_b64_tr_b16 v[120:121], v246 offset:16584
    v_mfma_f32_16x16x32_bf16 v[56:59], v[144:147], v[176:179], v[56:59]
    ds_read_b64_tr_b16 v[122:123], v246 offset:24264
    v_mfma_f32_16x16x32_bf16 v[52:55], v[144:147], v[172:175], v[52:55]
    ds_read_b128 v[100:103], v244 offset:26624
    ds_read_b64_tr_b16 v[124:125], v247 offset:16384
    v_mfma_f32_16x16x32_bf16 v[48:51], v[168:171], v[144:147], v[48:51]
    s_add_u32 m0, s49, 0
    s_movk_i32 s46, 1152
    s_mov_b64 exec, s[56:57]
    buffer_load_dwordx4 v184, s[24:27], s46 offen lds
    s_mov_b64 exec, -1
    v_mfma_f32_16x16x32_bf16 v[44:47], v[164:167], v[144:147], v[44:47]
    ds_read_b64_tr_b16 v[126:127], v247 offset:24064
    v_mfma_f32_16x16x32_bf16 v[40:43], v[160:163], v[144:147], v[40:43]
    ds_read_b64_tr_b16 v[128:129], v246 offset:16704
    ds_read_b64_tr_b16 v[130:131], v246 offset:24384
    v_mfma_f32_16x16x32_bf16 v[36:39], v[156:159], v[144:147], v[36:39]
    ds_read_b64_tr_b16 v[132:133], v246 offset:16744
    v_mfma_f32_16x16x32_bf16 v[32:35], v[152:155], v[144:147], v[32:35]
    s_add_u32 m0, s49, 8192
    s_movk_i32 s46, 1152
    buffer_load_dwordx4 v185, s[24:27], s46 offen lds
    v_mfma_f32_16x16x32_bf16 v[64:67], v[152:155], v[148:151], v[64:67]
    ds_read_b128 v[104:107], v244 offset:28672
    ds_read_b64_tr_b16 v[134:135], v246 offset:24424
    v_mfma_f32_16x16x32_bf16 v[68:71], v[156:159], v[148:151], v[68:71]
    v_mfma_f32_16x16x32_bf16 v[72:75], v[160:163], v[148:151], v[72:75]
    v_mfma_f32_16x16x32_bf16 v[76:79], v[164:167], v[148:151], v[76:79]
    s_add_u32 m0, s49, 16384
    s_movk_i32 s46, 1152
    buffer_load_dwordx4 v186, s[24:27], s46 offen lds
    v_mfma_f32_16x16x32_bf16 v[80:83], v[168:171], v[148:151], v[80:83]
    v_mfma_f32_16x16x32_bf16 v[84:87], v[148:151], v[172:175], v[84:87]
    v_mfma_f32_16x16x32_bf16 v[88:91], v[148:151], v[176:179], v[88:91]
    s_waitcnt vmcnt(16) lgkmcnt(0)
    s_barrier
    v_subrev_u32 v246, 49152, v246
    v_subrev_u32 v247, 49152, v247
    v_subrev_u32 v248, 49152, v248
    s_cmp_lt_u32 s40, 4
    s_cbranch_scc0 SK_40
    v_mfma_f32_16x16x32_bf16 v[28:31], v[96:99], v[136:139], v[28:31]
    ds_read_b64_tr_b16 v[180:181], v248 offset:0
    v_mfma_f32_16x16x32_bf16 v[60:63], v[100:103], v[136:139], v[60:63]
    ds_read_b64_tr_b16 v[182:183], v248 offset:7680
    v_mfma_f32_16x16x32_bf16 v[92:95], v[104:107], v[136:139], v[92:95]
SK_40:
    v_mfma_f32_16x16x32_bf16 v[0:3], v[108:111], v[96:99], v[0:3]
    ds_read_b64_tr_b16 v[152:153], v246 offset:0
    ds_read_b64_tr_b16 v[154:155], v246 offset:7680
    v_mfma_f32_16x16x32_bf16 v[4:7], v[112:115], v[96:99], v[4:7]
    s_add_u32 m0, s47, 65536
    s_mul_i32 s44, s45, 19
    buffer_load_dwordx4 v187, s[28:31], s44 offen lds
    v_mfma_f32_16x16x32_bf16 v[8:11], v[116:119], v[96:99], v[8:11]
    ds_read_b64_tr_b16 v[156:157], v246 offset:40
    ds_read_b128 v[140:143], v245 offset:24576
    v_mfma_f32_16x16x32_bf16 v[12:15], v[120:123], v[96:99], v[12:15]
    ds_read_b64_tr_b16 v[158:159], v246 offset:7720
    v_mfma_f32_16x16x32_bf16 v[16:19], v[124:127], v[96:99], v[16:19]
    ds_read_b64_tr_b16 v[160:161], v246 offset:160
    v_mfma_f32_16x16x32_bf16 v[20:23], v[96:99], v[128:131], v[20:23]
    ds_read_b64_tr_b16 v[162:163], v246 offset:7840
    s_add_u32 m0, s48, 65536
    s_mul_i32 s44, s45, 19
    buffer_load_dwordx4 v188, s[28:31], s44 offen lds
    v_mfma_f32_16x16x32_bf16 v[24:27], v[96:99], v[132:135], v[24:27]
    ds_read_b64_tr_b16 v[164:165], v246 offset:200
    v_mfma_f32_16x16x32_bf16 v[56:59], v[100:103], v[132:135], v[56:59]
    ds_read_b64_tr_b16 v[166:167], v246 offset:7880
    v_mfma_f32_16x16x32_bf16 v[52:55], v[100:103], v[128:131], v[52:55]
    ds_read_b128 v[144:147], v245 offset:26624
    ds_read_b64_tr_b16 v[168:169], v247 offset:0
    v_mfma_f32_16x16x32_bf16 v[48:51], v[124:127], v[100:103], v[48:51]
    buffer_load_dwordx4 v[216:219], v254, s[52:55], s88 offen offset:3072 sc1
    v_mfma_f32_16x16x32_bf16 v[44:47], v[120:123], v[100:103], v[44:47]
    ds_read_b64_tr_b16 v[170:171], v247 offset:7680
    v_mfma_f32_16x16x32_bf16 v[40:43], v[116:119], v[100:103], v[40:43]
    ds_read_b64_tr_b16 v[172:173], v246 offset:320
    ds_read_b64_tr_b16 v[174:175], v246 offset:8000
    v_mfma_f32_16x16x32_bf16 v[36:39], v[112:115], v[100:103], v[36:39]
    ds_read_b64_tr_b16 v[176:177], v246 offset:360
    v_mfma_f32_16x16x32_bf16 v[32:35], v[108:111], v[100:103], v[32:35]
    buffer_load_dwordx4 v[220:223], v254, s[52:55], s89 offen sc1
    v_mfma_f32_16x16x32_bf16 v[64:67], v[108:111], v[104:107], v[64:67]
    ds_read_b128 v[148:151], v245 offset:28672
    ds_read_b64_tr_b16 v[178:179], v246 offset:8040
    v_mfma_f32_16x16x32_bf16 v[68:71], v[112:115], v[104:107], v[68:71]
    v_mfma_f32_16x16x32_bf16 v[72:75], v[116:119], v[104:107], v[72:75]
    v_mfma_f32_16x16x32_bf16 v[76:79], v[120:123], v[104:107], v[76:79]
    s_add_u32 s88, s92, 2
    s_add_u32 s88, s88, s94
    s_mul_i32 s88, s88, 5120
    s_add_u32 s89, s88, 4096
    buffer_load_dwordx4 v[224:227], v254, s[52:55], s88 offen offset:0 sc1
    v_mfma_f32_16x16x32_bf16 v[80:83], v[124:127], v[104:107], v[80:83]
    v_mfma_f32_16x16x32_bf16 v[84:87], v[104:107], v[128:131], v[84:87]
    v_mfma_f32_16x16x32_bf16 v[88:91], v[104:107], v[132:135], v[88:91]
    s_waitcnt vmcnt(16) lgkmcnt(0)
    s_barrier
    s_cmp_lt_u32 s40, 4
    s_cbranch_scc0 SK_41
    v_mfma_f32_16x16x32_bf16 v[28:31], v[140:143], v[180:183], v[28:31]
    ds_read_b64_tr_b16 v[136:137], v248 offset:16384
    v_mfma_f32_16x16x32_bf16 v[60:63], v[144:147], v[180:183], v[60:63]
    ds_read_b64_tr_b16 v[138:139], v248 offset:24064
    v_mfma_f32_16x16x32_bf16 v[92:95], v[148:151], v[180:183], v[92:95]
SK_41:
    v_mfma_f32_16x16x32_bf16 v[0:3], v[152:155], v[140:143], v[0:3]
    ds_read_b64_tr_b16 v[108:109], v246 offset:16384
    ds_read_b64_tr_b16 v[110:111], v246 offset:24064
    v_mfma_f32_16x16x32_bf16 v[4:7], v[156:159], v[140:143], v[4:7]
    s_add_u32 s44, s93, 7
    s_add_u32 s44, s44, s94
    s_mul_i32 s44, s44, 5120
    s_add_u32 m0, s49, 73728
    s_nop 0
    buffer_load_dwordx4 v254, s[52:55], s44 offen sc1 lds
    v_mfma_f32_16x16x32_bf16 v[8:11], v[160:163], v[140:143], v[8:11]
    ds_read_b64_tr_b16 v[112:113], v246 offset:16424
    ds_read_b128 v[96:99], v244 offset:49152
    v_mfma_f32_16x16x32_bf16 v[12:15], v[164:167], v[140:143], v[12:15]
    ds_read_b64_tr_b16 v[114:115], v246 offset:24104
    v_mfma_f32_16x16x32_bf16 v[16:19], v[168:171], v[140:143], v[16:19]
    ds_read_b64_tr_b16 v[116:117], v246 offset:16544
    v_mfma_f32_16x16x32_bf16 v[20:23], v[140:143], v[172:175], v[20:23]
    ds_read_b64_tr_b16 v[118:119], v246 offset:24224
    s_add_u32 s44, s44, 1024
    s_add_u32 m0, s49, 81920
    s_nop 0
    buffer_load_dwordx4 v254, s[52:55], s44 offen sc1 lds
    v_mfma_f32_16x16x32_bf16 v[24:27], v[140:143], v[176:179], v[24:27]
    ds_read_b64_tr_b16 v[120:121], v246 offset:16584
    v_mfma_f32_16x16x32_bf16 v[56:59], v[144:147], v[176:179], v[56:59]
    ds_read_b64_tr_b16 v[122:123], v246 offset:24264
    ds_read_b128 v[100:103], v244 offset:51200
    v_mfma_f32_16x16x32_bf16 v[52:55], v[144:147], v[172:175], v[52:55]
    ds_read_b64_tr_b16 v[124:125], v247 offset:16384
    v_mfma_f32_16x16x32_bf16 v[48:51], v[168:171], v[144:147], v[48:51]
    s_add_u32 s45, s92, 5
    s_add_u32 s45, s45, s94
    s_mul_i32 s45, s45, 5120
    s_add_u32 m0, s49, 24576
    s_nop 0
    buffer_load_dwordx4 v254, s[52:55], s45 offen sc1 lds
    v_mfma_f32_16x16x32_bf16 v[44:47], v[164:167], v[144:147], v[44:47]
    s_sub_u32 s70, s40, 1
    s_cmp_lt_u32 s70, 3
    s_cbranch_scc0 SK_23
    s_mul_i32 s68, s41, 176
    s_sub_u32 s68, s68, 16
    s_lshl_b32 s68, s68, 4
    s_lshl_b32 s70, s70, 10
    s_add_u32 s68, s68, s70
    v_add_u32 v253, s68, v254
    s_add_u32 s70, s70, 157696
    v_add_u32 v250, s70, v254
    buffer_load_dwordx4 v[236:239], v253, s[32:35], 0 offen sc1
SK_23:
    ds_read_b64_tr_b16 v[126:127], v247 offset:24064
    v_mfma_f32_16x16x32_bf16 v[40:43], v[160:163], v[144:147], v[40:43]
    ds_read_b64_tr_b16 v[128:129], v246 offset:16704
    v_mfma_f32_16x16x32_bf16 v[36:39], v[156:159], v[144:147], v[36:39]
    ds_read_b64_tr_b16 v[130:131], v246 offset:24384
    ds_read_b64_tr_b16 v[132:133], v246 offset:16744
    v_mfma_f32_16x16x32_bf16 v[32:35], v[152:155], v[144:147], v[32:35]
    s_add_u32 s45, s45, 1024
    s_add_u32 m0, s49, 32768
    s_nop 0
    buffer_load_dwordx4 v254, s[52:55], s45 offen sc1 lds
    v_mfma_f32_16x16x32_bf16 v[64:67], v[152:155], v[148:151], v[64:67]
    ds_read_b128 v[104:107], v244 offset:53248
    v_mfma_f32_16x16x32_bf16 v[68:71], v[156:159], v[148:151], v[68:71]
    ds_read_b64_tr_b16 v[134:135], v246 offset:24424
    v_mfma_f32_16x16x32_bf16 v[72:75], v[160:163], v[148:151], v[72:75]
    v_mfma_f32_16x16x32_bf16 v[76:79], v[164:167], v[148:151], v[76:79]
    s_add_u32 s45, s45, 1024
    s_add_u32 m0, s49, 40960
    s_nop 0
    buffer_load_dwordx4 v254, s[52:55], s45 offen sc1 lds
    v_mfma_f32_16x16x32_bf16 v[80:83], v[168:171], v[148:151], v[80:83]
    v_mfma_f32_16x16x32_bf16 v[84:87], v[148:151], v[172:175], v[84:87]
    v_mfma_f32_16x16x32_bf16 v[88:91], v[148:151], v[176:179], v[88:91]
    s_waitcnt vmcnt(18) lgkmcnt(0)
    s_barrier
    s_cmp_lt_u32 s40, 4
    s_cbranch_scc0 SK_42
    v_mfma_f32_16x16x32_bf16 v[28:31], v[96:99], v[136:139], v[28:31]
    ds_read_b64_tr_b16 v[180:181], v248 offset:32768
    v_mfma_f32_16x16x32_bf16 v[60:63], v[100:103], v[136:139], v[60:63]
    ds_read_b64_tr_b16 v[182:183], v248 offset:40448
    v_mfma_f32_16x16x32_bf16 v[92:95], v[104:107], v[136:139], v[92:95]
SK_42:
    v_mfma_f32_16x16x32_bf16 v[0:3], v[108:111], v[96:99], v[0:3]
    ds_read_b64_tr_b16 v[152:153], v246 offset:32768
    ds_read_b64_tr_b16 v[154:155], v246 offset:40448
    v_mfma_f32_16x16x32_bf16 v[4:7], v[112:115], v[96:99], v[4:7]
    s_add_u32 s44, s44, 1024
    s_add_u32 m0, s49, 90112
    s_nop 0
    buffer_load_dwordx4 v254, s[52:55], s44 offen sc1 lds
    v_mfma_f32_16x16x32_bf16 v[8:11], v[116:119], v[96:99], v[8:11]
    ds_read_b64_tr_b16 v[156:157], v246 offset:32808
    ds_read_b128 v[140:143], v245 offset:49152
    v_mfma_f32_16x16x32_bf16 v[12:15], v[120:123], v[96:99], v[12:15]
    ds_read_b64_tr_b16 v[158:159], v246 offset:40488
    v_mfma_f32_16x16x32_bf16 v[16:19], v[124:127], v[96:99], v[16:19]
    ds_read_b64_tr_b16 v[160:161], v246 offset:32928
    v_mfma_f32_16x16x32_bf16 v[20:23], v[96:99], v[128:131], v[20:23]
    ds_read_b64_tr_b16 v[162:163], v246 offset:40608
    s_add_u32 s44, s44, 1024
    s_add_u32 m0, s49, 98304
    s_nop 0
    buffer_load_dwordx4 v254, s[52:55], s44 offen sc1 lds
    v_mfma_f32_16x16x32_bf16 v[24:27], v[96:99], v[132:135], v[24:27]
    ds_read_b64_tr_b16 v[164:165], v246 offset:32968
    v_mfma_f32_16x16x32_bf16 v[56:59], v[100:103], v[132:135], v[56:59]
    ds_read_b64_tr_b16 v[166:167], v246 offset:40648
    v_mfma_f32_16x16x32_bf16 v[52:55], v[100:103], v[128:131], v[52:55]
    ds_read_b128 v[144:147], v245 offset:51200
    ds_read_b64_tr_b16 v[168:169], v247 offset:32768
    v_mfma_f32_16x16x32_bf16 v[48:51], v[124:127], v[100:103], v[48:51]
    buffer_load_dwordx4 v[228:231], v254, s[52:55], s88 offen offset:1024 sc1
    v_mfma_f32_16x16x32_bf16 v[44:47], v[120:123], v[100:103], v[44:47]
    ds_read_b64_tr_b16 v[170:171], v247 offset:40448
    v_mfma_f32_16x16x32_bf16 v[40:43], v[116:119], v[100:103], v[40:43]
    ds_read_b64_tr_b16 v[172:173], v246 offset:33088
    ds_read_b64_tr_b16 v[174:175], v246 offset:40768
    v_mfma_f32_16x16x32_bf16 v[36:39], v[112:115], v[100:103], v[36:39]
    ds_read_b64_tr_b16 v[176:177], v246 offset:33128
    v_mfma_f32_16x16x32_bf16 v[32:35], v[108:111], v[100:103], v[32:35]
    buffer_load_dwordx4 v[232:235], v254, s[52:55], s88 offen offset:2048 sc1
    v_mfma_f32_16x16x32_bf16 v[64:67], v[108:111], v[104:107], v[64:67]
    ds_read_b128 v[148:151], v245 offset:53248
    ds_read_b64_tr_b16 v[178:179], v246 offset:40808
    v_mfma_f32_16x16x32_bf16 v[68:71], v[112:115], v[104:107], v[68:71]
    v_mfma_f32_16x16x32_bf16 v[72:75], v[116:119], v[104:107], v[72:75]
    v_mfma_f32_16x16x32_bf16 v[76:79], v[120:123], v[104:107], v[76:79]
    s_add_u32 s88, s92, 0
    s_add_u32 s88, s88, s94
    s_mul_i32 s88, s88, 5120
    s_add_u32 s89, s88, 4096
    buffer_load_dwordx4 v[184:187], v254, s[52:55], s88 offen offset:0 sc1
    v_mfma_f32_16x16x32_bf16 v[80:83], v[124:127], v[104:107], v[80:83]
    v_mfma_f32_16x16x32_bf16 v[84:87], v[104:107], v[128:131], v[84:87]
    v_mfma_f32_16x16x32_bf16 v[88:91], v[104:107], v[132:135], v[88:91]
    s_waitcnt vmcnt(15) lgkmcnt(0)
    s_barrier
    v_add_u32 v246, 49152, v246
    v_add_u32 v247, 49152, v247
    v_add_u32 v248, 49152, v248
    s_cmp_lt_u32 s40, 4
    s_cbranch_scc0 SK_43
    v_mfma_f32_16x16x32_bf16 v[28:31], v[140:143], v[180:183], v[28:31]
    ds_read_b64_tr_b16 v[136:137], v248 offset:0
    v_mfma_f32_16x16x32_bf16 v[60:63], v[144:147], v[180:183], v[60:63]
    ds_read_b64_tr_b16 v[138:139], v248 offset:7680
    v_mfma_f32_16x16x32_bf16 v[92:95], v[148:151], v[180:183], v[92:95]
SK_43:
    v_mfma_f32_16x16x32_bf16 v[0:3], v[152:155], v[140:143], v[0:3]
    ds_read_b64_tr_b16 v[108:109], v246 offset:0
    ds_read_b64_tr_b16 v[110:111], v246 offset:7680
    v_mfma_f32_16x16x32_bf16 v[4:7], v[156:159], v[140:143], v[4:7]
    s_add_u32 s44, s44, 1024
    s_add_u32 m0, s49, 106496
    s_nop 0
    buffer_load_dwordx4 v254, s[52:55], s44 offen sc1 lds
    v_mfma_f32_16x16x32_bf16 v[8:11], v[160:163], v[140:143], v[8:11]
    ds_read_b64_tr_b16 v[112:113], v246 offset:40
    ds_read_b128 v[96:99], v244 offset:0
    v_mfma_f32_16x16x32_bf16 v[12:15], v[164:167], v[140:143], v[12:15]
    ds_read_b64_tr_b16 v[114:115], v246 offset:7720
    v_mfma_f32_16x16x32_bf16 v[16:19], v[168:171], v[140:143], v[16:19]
    ds_read_b64_tr_b16 v[116:117], v246 offset:160
    s_sub_u32 s70, s40, 1
    s_cmp_lt_u32 s70, 3
    s_cbranch_scc0 SK_24
    s_waitcnt vmcnt(8)
    v_mov_b32 v240, v236
    v_mov_b32 v241, v236
    v_mov_b32 v242, v238
    v_mov_b32 v243, v238
    v_mov_b32 v238, v237
    v_mov_b32 v236, v239
    v_mov_b32 v237, v239
    v_mov_b32 v239, v238
    ds_write_b128 v250, v[240:243]
    ds_write_b128 v250, v[236:239] offset:3072
SK_24:
    v_mfma_f32_16x16x32_bf16 v[20:23], v[140:143], v[172:175], v[20:23]
    ds_read_b64_tr_b16 v[118:119], v246 offset:7840
    v_mfma_f32_16x16x32_bf16 v[24:27], v[140:143], v[176:179], v[24:27]
    s_add_u32 s44, s93, 8
    s_add_u32 s44, s44, s94
    s_mul_i32 s44, s44, 5120
    s_add_u32 m0, s49, 114688
    s_nop 0
    buffer_load_dwordx4 v254, s[52:55], s44 offen sc1 lds
    ds_read_b64_tr_b16 v[120:121], v246 offset:200
    v_mfma_f32_16x16x32_bf16 v[56:59], v[144:147], v[176:179], v[56:59]
    ds_read_b64_tr_b16 v[122:123], v246 offset:7880
    v_mfma_f32_16x16x32_bf16 v[52:55], v[144:147], v[172:175], v[52:55]
    ds_read_b128 v[100:103], v244 offset:2048
    ds_read_b64_tr_b16 v[124:125], v247 offset:0
    v_mfma_f32_16x16x32_bf16 v[48:51], v[168:171], v[144:147], v[48:51]
    s_add_u32 s45, s45, 1024
    s_add_u32 m0, s49, 49152
    s_nop 0
    buffer_load_dwordx4 v254, s[52:55], s45 offen sc1 lds
    v_mfma_f32_16x16x32_bf16 v[44:47], v[164:167], v[144:147], v[44:47]
    ds_read_b64_tr_b16 v[126:127], v247 offset:7680
    v_mfma_f32_16x16x32_bf16 v[40:43], v[160:163], v[144:147], v[40:43]
    ds_read_b64_tr_b16 v[128:129], v246 offset:320
    ds_read_b64_tr_b16 v[130:131], v246 offset:8000
    v_mfma_f32_16x16x32_bf16 v[36:39], v[156:159], v[144:147], v[36:39]
    ds_read_b64_tr_b16 v[132:133], v246 offset:360
    v_mfma_f32_16x16x32_bf16 v[32:35], v[152:155], v[144:147], v[32:35]
    s_add_u32 s45, s45, 1024
    s_add_u32 m0, s49, 57344
    s_nop 0
    buffer_load_dwordx4 v254, s[52:55], s45 offen sc1 lds
    ds_read_b128 v[104:107], v244 offset:4096
    v_mfma_f32_16x16x32_bf16 v[64:67], v[152:155], v[148:151], v[64:67]
    ds_read_b64_tr_b16 v[134:135], v246 offset:8040
    v_mfma_f32_16x16x32_bf16 v[68:71], v[156:159], v[148:151], v[68:71]
    s_and_b32 s76, s40, 3
    s_mul_i32 s97, s41, 11
    s_mul_i32 s71, s76, 3
    s_add_u32 s97, s97, s71
    s_sub_u32 s97, s97, 1
    s_add_u32 s98, s97, 1
    s_add_u32 s99, s97, 2
    s_and_b32 s69, s76, 1
    s_lshl_b32 s71, s71, 8
    s_add_u32 s71, s71, 157696
    v_mfma_f32_16x16x32_bf16 v[72:75], v[160:163], v[148:151], v[72:75]
    v_mfma_f32_16x16x32_bf16 v[76:79], v[164:167], v[148:151], v[76:79]
    s_mov_b32 s45, s95
    s_add_u32 s45, s45, s94
    s_mul_i32 s45, s45, 5120
    s_add_u32 m0, s49, 65536
    s_nop 0
    buffer_load_dwordx4 v254, s[52:55], s45 offen sc1 lds
    v_mfma_f32_16x16x32_bf16 v[80:83], v[168:171], v[148:151], v[80:83]
    v_mfma_f32_16x16x32_bf16 v[84:87], v[148:151], v[172:175], v[84:87]
    v_mfma_f32_16x16x32_bf16 v[88:91], v[148:151], v[176:179], v[88:91]
    s_waitcnt vmcnt(18) lgkmcnt(0)
    s_barrier
    s_cmp_lt_u32 s40, 4
    s_cbranch_scc0 SK_44
    v_mfma_f32_16x16x32_bf16 v[28:31], v[96:99], v[136:139], v[28:31]
    ds_read_b64_tr_b16 v[180:181], v248 offset:16384
    v_mfma_f32_16x16x32_bf16 v[60:63], v[100:103], v[136:139], v[60:63]
    ds_read_b64_tr_b16 v[182:183], v248 offset:24064
    v_mfma_f32_16x16x32_bf16 v[92:95], v[104:107], v[136:139], v[92:95]
SK_44:
    v_mfma_f32_16x16x32_bf16 v[0:3], v[108:111], v[96:99], v[0:3]
    ds_read_b64_tr_b16 v[152:153], v246 offset:16384
    ds_read_b64_tr_b16 v[154:155], v246 offset:24064
    v_mfma_f32_16x16x32_bf16 v[4:7], v[112:115], v[96:99], v[4:7]
    buffer_load_dwordx4 v[188:191], v254, s[52:55], s88 offen offset:1024 sc1
    s_lshr_b32 s77, s40, 2
    s_mov_b32 s72, 0x0000ffff
    s_mov_b32 s73, 0
    s_mov_b32 s74, 0xffff0000
    s_mov_b32 s75, 0
    v_mfma_f32_16x16x32_bf16 v[8:11], v[116:119], v[96:99], v[8:11]
    ds_read_b64_tr_b16 v[156:157], v246 offset:16424
    v_mfma_f32_16x16x32_bf16 v[12:15], v[120:123], v[96:99], v[12:15]
    ds_read_b128 v[140:143], v245 offset:0
    ds_read_b64_tr_b16 v[158:159], v246 offset:24104
    v_mfma_f32_16x16x32_bf16 v[16:19], v[124:127], v[96:99], v[16:19]
    ds_read_b64_tr_b16 v[160:161], v246 offset:16544
    ds_read_b64_tr_b16 v[162:163], v246 offset:24224
    v_mfma_f32_16x16x32_bf16 v[20:23], v[96:99], v[128:131], v[20:23]
    s_add_u32 s44, s44, 1024
    s_add_u32 m0, s49, 122880
    s_nop 0
    buffer_load_dwordx4 v254, s[52:55], s44 offen sc1 lds
    v_mfma_f32_16x16x32_bf16 v[24:27], v[96:99], v[132:135], v[24:27]
    s_mov_b32 s78, 0x00ff00ff
    s_mov_b32 s79, 0xff00ff00
    s_mov_b32 s80, 0xff00ff00
    s_mov_b32 s81, 0x00ff00ff
    ds_read_b64_tr_b16 v[164:165], v246 offset:16584
    v_mfma_f32_16x16x32_bf16 v[56:59], v[100:103], v[132:135], v[56:59]
    ds_read_b64_tr_b16 v[166:167], v246 offset:24264
    ds_read_b128 v[144:147], v245 offset:2048
    v_mfma_f32_16x16x32_bf16 v[52:55], v[100:103], v[128:131], v[52:55]
    ds_read_b64_tr_b16 v[168:169], v247 offset:16384
    v_mfma_f32_16x16x32_bf16 v[48:51], v[124:127], v[100:103], v[48:51]
    s_add_u32 s44, s44, 1024
    s_add_u32 m0, s49, 131072
    s_nop 0
    buffer_load_dwordx4 v254, s[52:55], s44 offen sc1 lds
    s_mov_b32 s82, 0x3ea52b5c
    s_mov_b32 s83, 0x3ea52b5c
    s_lshl_b32 s86, s42, 1
    s_add_u32 s86, s86, s77
    s_lshl_b32 s86, s86, 10
    v_mfma_f32_16x16x32_bf16 v[44:47], v[120:123], v[100:103], v[44:47]
    ds_read_b64_tr_b16 v[170:171], v247 offset:24064
    ds_read_b64_tr_b16 v[172:173], v246 offset:16704
    v_mfma_f32_16x16x32_bf16 v[40:43], v[116:119], v[100:103], v[40:43]
    ds_read_b64_tr_b16 v[174:175], v246 offset:24384
    v_mfma_f32_16x16x32_bf16 v[36:39], v[112:115], v[100:103], v[36:39]
    ds_read_b64_tr_b16 v[176:177], v246 offset:16744
    buffer_load_dwordx4 v[192:195], v254, s[52:55], s88 offen offset:2048 sc1
    v_mfma_f32_16x16x32_bf16 v[32:35], v[108:111], v[100:103], v[32:35]
    s_lshr_b32 s87, s42, 1
    s_add_u32 s87, s87, 16
    s_lshl_b32 s87, s87, 10
    s_lshl_b32 s96, s41, 7
    s_add_u32 s96, s96, 4096
    ds_read_b128 v[148:151], v245 offset:4096
    v_mfma_f32_16x16x32_bf16 v[64:67], v[108:111], v[104:107], v[64:67]
    ds_read_b64_tr_b16 v[178:179], v246 offset:24424
    v_mfma_f32_16x16x32_bf16 v[68:71], v[112:115], v[104:107], v[68:71]
    v_mfma_f32_16x16x32_bf16 v[72:75], v[116:119], v[104:107], v[72:75]
    buffer_load_dwordx4 v[196:199], v254, s[52:55], s88 offen offset:3072 sc1
    v_mfma_f32_16x16x32_bf16 v[76:79], v[120:123], v[104:107], v[76:79]
    s_mov_b32 s84, 0x00010001
    s_mov_b32 s85, 0x00010001
    v_mfma_f32_16x16x32_bf16 v[80:83], v[124:127], v[104:107], v[80:83]
    v_mfma_f32_16x16x32_bf16 v[84:87], v[104:107], v[128:131], v[84:87]
    s_lshl_b32 s68, s90, 6
    s_mul_i32 s70, s68, 5578
    s_lshr_b32 s70, s70, 20
    s_mul_i32 s47, s68, 5958
    s_lshr_b32 s47, s47, 20
    s_add_u32 s70, s70, 16
    s_add_u32 s47, s47, 32
    v_mov_b32 v250, s70
    v_writelane_b32 v250, s47, 2
    s_add_u32 s68, s68, 63
    s_mul_i32 s70, s68, 5578
    s_lshr_b32 s70, s70, 20
    s_mul_i32 s47, s68, 5958
    s_lshr_b32 s47, s47, 20
    s_add_u32 s70, s70, 16
    s_add_u32 s47, s47, 32
    v_writelane_b32 v250, s70, 1
    v_writelane_b32 v250, s47, 3
    v_lshlrev_b32 v250, 7, v250
    v_mfma_f32_16x16x32_bf16 v[88:91], v[104:107], v[132:135], v[88:91]
    s_waitcnt lgkmcnt(0)
    s_barrier
    s_cmp_lt_u32 s40, 4
    s_cbranch_scc0 SK_45
    v_mfma_f32_16x16x32_bf16 v[28:31], v[140:143], v[180:183], v[28:31]
    v_mfma_f32_16x16x32_bf16 v[60:63], v[144:147], v[180:183], v[60:63]
    v_mfma_f32_16x16x32_bf16 v[92:95], v[148:151], v[180:183], v[92:95]
SK_45:
    v_mfma_f32_16x16x32_bf16 v[0:3], v[152:155], v[140:143], v[0:3]
    v_and_b32 v128, 7, v255
    v_bfe_u32 v129, v255, 3, 1
    v_xor_b32 v129, s69, v129
    s_lshl_b32 s68, s77, 9
    s_add_u32 s68, s68, 155648
    v_and_b32 v136, 48, v255
    v_add_u32 v134, s68, v136
    v_and_b32 v135, 15, v255
    v_lshl_add_u32 v135, v135, 2, s68
    v_mfma_f32_16x16x32_bf16 v[4:7], v[156:159], v[140:143], v[4:7]
    buffer_load_dwordx4 v[200:203], v254, s[52:55], s89 offen sc1
    v_mfma_f32_16x16x32_bf16 v[8:11], v[160:163], v[140:143], v[8:11]
    v_lshl_add_u32 v132, v128, 1, v129
    v_xor_b32 v133, 1, v132
    v_lshrrev_b32 v128, 5, v255
    v_mfma_f32_16x16x32_bf16 v[12:15], v[164:167], v[140:143], v[12:15]
    s_mul_i32 s68, s40, 3072
    v_lshl_add_u32 v248, v255, 3, s68
    v_mfma_f32_16x16x32_bf16 v[16:19], v[168:171], v[140:143], v[16:19]
    v_xor_b32 v128, s69, v128
    v_bfe_u32 v129, v255, 4, 1
    v_lshl_add_u32 v128, v129, 3, v128
    s_add_u32 s68, s40, 1
    s_and_b32 s68, s68, 7
    s_mul_i32 s68, s68, 3072
    v_lshl_add_u32 v249, v255, 3, s68
    v_mfma_f32_16x16x32_bf16 v[20:23], v[140:143], v[172:175], v[20:23]
    s_add_u32 s44, s44, 1024
    s_add_u32 m0, s49, 139264
    s_nop 0
    buffer_load_dwordx4 v254, s[52:55], s44 offen sc1 lds
    v_mfma_f32_16x16x32_bf16 v[24:27], v[140:143], v[176:179], v[24:27]
    v_xor_b32 v129, 1, v128
    v_lshl_add_u32 v108, v128, 4, s71
    v_lshl_add_u32 v109, v129, 4, s71
    v_mfma_f32_16x16x32_bf16 v[56:59], v[144:147], v[176:179], v[56:59]
    s_and_b32 s68, s42, 1
    s_lshl_b32 s68, s68, 1
    s_add_u32 s68, s68, s77
    s_lshl_b32 s68, s68, 6
    v_and_b32 v245, 12, v132
    v_and_b32 v247, 3, v132
    v_lshl_add_u32 v245, v245, 2, v247
    v_lshlrev_b32 v245, 4, v245
    v_mfma_f32_16x16x32_bf16 v[52:55], v[144:147], v[172:175], v[52:55]
    v_lshl_add_u32 v130, v132, 4, s71
    v_lshl_add_u32 v131, v133, 4, s71
    ds_read_b64 v[104:105], v130 offset:512
    ds_read_b64 v[106:107], v130 offset:3592
    v_mfma_f32_16x16x32_bf16 v[48:51], v[168:171], v[144:147], v[48:51]
    s_add_u32 s44, s44, 1024
    s_add_u32 m0, s49, 147456
    s_nop 0
    buffer_load_dwordx4 v254, s[52:55], s44 offen sc1 lds
    v_mfma_f32_16x16x32_bf16 v[44:47], v[164:167], v[144:147], v[44:47]
    v_lshl_add_u32 v244, v136, 2, v245
    v_add_u32 v246, s68, v245
    v_xor_b32 v245, 16, v244
    v_xor_b32 v247, 16, v246
    v_mfma_f32_16x16x32_bf16 v[40:43], v[160:163], v[144:147], v[40:43]
    ds_read_b64 v[100:101], v131 offset:256
    ds_read_b64 v[102:103], v131 offset:3336
    v_mfma_f32_16x16x32_bf16 v[36:39], v[156:159], v[144:147], v[36:39]
    s_cmp_eq_u32 s76, 0
    s_cbranch_scc0 SK_25
    s_mov_b64 exec, s[84:85]
    ds_write_b128 v134, v[0:3] offset:0
    ds_write_b128 v134, v[4:7] offset:64
    ds_write_b128 v134, v[8:11] offset:128
    ds_write_b128 v134, v[12:15] offset:192
    ds_write_b128 v134, v[16:19] offset:256
    s_mov_b64 exec, 0xffff
    ds_write_b32 v135, v20 offset:320
    ds_write_b32 v135, v24 offset:384
    ds_write_b32 v135, v28 offset:448
    s_mov_b64 exec, -1
SK_25:
    ds_read_b64 v[96:97], v130 offset:0
    ds_read_b64 v[98:99], v130 offset:3080
    v_mfma_f32_16x16x32_bf16 v[32:35], v[152:155], v[144:147], v[32:35]
    s_add_u32 s88, s92, 2
    s_add_u32 s88, s88, s94
    s_mul_i32 s88, s88, 5120
    s_add_u32 s89, s88, 4096
    buffer_load_dwordx4 v[236:239], v254, s[52:55], s88 offen offset:3072 sc1
    v_mfma_f32_16x16x32_bf16 v[64:67], v[152:155], v[148:151], v[64:67]
    v_mfma_f32_16x16x32_bf16 v[68:71], v[156:159], v[148:151], v[68:71]
    v_mfma_f32_16x16x32_bf16 v[72:75], v[160:163], v[148:151], v[72:75]
    s_waitcnt lgkmcnt(0)
    s_barrier
    ds_read_b128 v[110:113], v134 offset:0
    ds_read_b128 v[114:117], v134 offset:64
    ds_read_b128 v[118:121], v134 offset:128
    ds_read_b128 v[122:125], v134 offset:192
    ds_read_b128 v[126:129], v134 offset:256
    ds_read2_b32 v[130:131], v135 offset0:80 offset1:80
    ds_read2_b32 v[132:133], v135 offset0:96 offset1:96
    ds_read2_b32 v[138:139], v135 offset0:112 offset1:112
    v_mfma_f32_16x16x32_bf16 v[76:79], v[164:167], v[148:151], v[76:79]
    buffer_load_dwordx4 v[240:243], v254, s[52:55], s89 offen sc1
    v_mfma_f32_16x16x32_bf16 v[80:83], v[168:171], v[148:151], v[80:83]
    v_mfma_f32_16x16x32_bf16 v[84:87], v[148:151], v[172:175], v[84:87]
    v_mfma_f32_16x16x32_bf16 v[88:91], v[148:151], v[176:179], v[88:91]
    v_add_u32 v166, 3080, v108
    v_add_u32 v167, 3080, v109
    ds_read2_b32 v[150:151], v108 offset0:128 offset1:136
    ds_read2_b32 v[162:163], v166 offset0:128 offset1:136
    ds_read2_b32 v[152:153], v108 offset0:144 offset1:152
    ds_read2_b32 v[164:165], v166 offset0:144 offset1:152
    ds_read2_b32 v[146:147], v109 offset0:64 offset1:72
    ds_read2_b32 v[158:159], v167 offset0:64 offset1:72
    ds_read2_b32 v[148:149], v109 offset0:80 offset1:88
    ds_read2_b32 v[160:161], v167 offset0:80 offset1:88
    ds_read2_b32 v[142:143], v108 offset0:0 offset1:8
    ds_read2_b32 v[154:155], v166 offset0:0 offset1:8
    ds_read2_b32 v[144:145], v108 offset0:16 offset1:24
    ds_read2_b32 v[156:157], v166 offset0:16 offset1:24
    s_waitcnt lgkmcnt(12)
    v_pk_fma_f32 v[0:1], v[96:97], v[110:111], v[0:1] neg_lo:[1,0,0] neg_hi:[1,0,0]
    v_pk_fma_f32 v[2:3], v[96:97], v[112:113], v[2:3] neg_lo:[1,0,0] neg_hi:[1,0,0]
    v_pk_mul_f32 v[0:1], v[0:1], v[98:99]
    v_pk_mul_f32 v[2:3], v[2:3], v[98:99]
    v_pk_fma_f32 v[4:5], v[96:97], v[114:115], v[4:5] neg_lo:[1,0,0] neg_hi:[1,0,0]
    v_pk_fma_f32 v[6:7], v[96:97], v[116:117], v[6:7] neg_lo:[1,0,0] neg_hi:[1,0,0]
    v_pk_mul_f32 v[4:5], v[4:5], v[98:99]
    v_pk_mul_f32 v[6:7], v[6:7], v[98:99]
    v_pk_fma_f32 v[8:9], v[96:97], v[118:119], v[8:9] neg_lo:[1,0,0] neg_hi:[1,0,0]
    v_pk_fma_f32 v[10:11], v[96:97], v[120:121], v[10:11] neg_lo:[1,0,0] neg_hi:[1,0,0]
    v_pk_mul_f32 v[8:9], v[8:9], v[98:99]
    v_pk_mul_f32 v[10:11], v[10:11], v[98:99]
    v_pk_fma_f32 v[12:13], v[96:97], v[122:123], v[12:13] neg_lo:[1,0,0] neg_hi:[1,0,0]
    v_pk_fma_f32 v[14:15], v[96:97], v[124:125], v[14:15] neg_lo:[1,0,0] neg_hi:[1,0,0]
    v_pk_mul_f32 v[12:13], v[12:13], v[98:99]
    v_pk_mul_f32 v[14:15], v[14:15], v[98:99]
    v_pk_fma_f32 v[16:17], v[96:97], v[126:127], v[16:17] neg_lo:[1,0,0] neg_hi:[1,0,0]
    v_pk_fma_f32 v[18:19], v[96:97], v[128:129], v[18:19] neg_lo:[1,0,0] neg_hi:[1,0,0]
    v_pk_mul_f32 v[16:17], v[16:17], v[98:99]
    v_pk_mul_f32 v[18:19], v[18:19], v[98:99]
    s_waitcnt lgkmcnt(8)
    v_pk_fma_f32 v[84:85], v[150:151], v[130:131], v[84:85] neg_lo:[1,0,0] neg_hi:[1,0,0]
    v_pk_fma_f32 v[86:87], v[152:153], v[130:131], v[86:87] neg_lo:[1,0,0] neg_hi:[1,0,0]
    v_pk_mul_f32 v[84:85], v[84:85], v[162:163]
    v_pk_mul_f32 v[86:87], v[86:87], v[164:165]
    v_cvt_pk_bf16_f32 v174, v84, v85
    v_cvt_pk_bf16_f32 v175, v86, v87
    v_pk_fma_f32 v[88:89], v[150:151], v[132:133], v[88:89] neg_lo:[1,0,0] neg_hi:[1,0,0]
    v_pk_fma_f32 v[90:91], v[152:153], v[132:133], v[90:91] neg_lo:[1,0,0] neg_hi:[1,0,0]
    v_pk_mul_f32 v[88:89], v[88:89], v[162:163]
    v_pk_mul_f32 v[90:91], v[90:91], v[164:165]
    v_cvt_pk_bf16_f32 v182, v88, v89
    v_cvt_pk_bf16_f32 v183, v90, v91
    v_pk_fma_f32 v[72:73], v[104:105], v[118:119], v[72:73] neg_lo:[1,0,0] neg_hi:[1,0,0]
    v_pk_fma_f32 v[74:75], v[104:105], v[120:121], v[74:75] neg_lo:[1,0,0] neg_hi:[1,0,0]
    v_pk_mul_f32 v[72:73], v[72:73], v[106:107]
    v_pk_mul_f32 v[74:75], v[74:75], v[106:107]
    v_cvt_pk_bf16_f32 v84, v72, v73
    v_cvt_pk_bf16_f32 v85, v74, v75
    v_pk_fma_f32 v[76:77], v[104:105], v[122:123], v[76:77] neg_lo:[1,0,0] neg_hi:[1,0,0]
    v_pk_fma_f32 v[78:79], v[104:105], v[124:125], v[78:79] neg_lo:[1,0,0] neg_hi:[1,0,0]
    v_pk_mul_f32 v[76:77], v[76:77], v[106:107]
    v_pk_mul_f32 v[78:79], v[78:79], v[106:107]
    v_cvt_pk_bf16_f32 v88, v76, v77
    v_cvt_pk_bf16_f32 v89, v78, v79
    v_pk_fma_f32 v[80:81], v[104:105], v[126:127], v[80:81] neg_lo:[1,0,0] neg_hi:[1,0,0]
    v_pk_fma_f32 v[82:83], v[104:105], v[128:129], v[82:83] neg_lo:[1,0,0] neg_hi:[1,0,0]
    v_pk_mul_f32 v[80:81], v[80:81], v[106:107]
    v_pk_mul_f32 v[82:83], v[82:83], v[106:107]
    v_cvt_pk_bf16_f32 v140, v80, v81
    v_cvt_pk_bf16_f32 v141, v82, v83
    v_cndmask_b32 v74, 0, v140, s[72:73]
    v_cndmask_b32 v76, 0, v140, s[74:75]
    v_mov_b32 v86, v140
    v_cndmask_b32 v75, 0, v141, s[72:73]
    v_cndmask_b32 v77, 0, v141, s[74:75]
    v_mov_b32 v87, v141
    v_pk_fma_f32 v[64:65], v[104:105], v[110:111], v[64:65] neg_lo:[1,0,0] neg_hi:[1,0,0]
    v_pk_fma_f32 v[66:67], v[104:105], v[112:113], v[66:67] neg_lo:[1,0,0] neg_hi:[1,0,0]
    v_pk_mul_f32 v[64:65], v[64:65], v[106:107]
    v_pk_mul_f32 v[66:67], v[66:67], v[106:107]
    v_cvt_pk_bf16_f32 v72, v64, v65
    v_cvt_pk_bf16_f32 v73, v66, v67
    v_permlane32_swap_b32 v140, v86
    v_permlane32_swap_b32 v141, v87
    v_pk_fma_f32 v[68:69], v[104:105], v[114:115], v[68:69] neg_lo:[1,0,0] neg_hi:[1,0,0]
    v_pk_fma_f32 v[70:71], v[104:105], v[116:117], v[70:71] neg_lo:[1,0,0] neg_hi:[1,0,0]
    v_pk_mul_f32 v[68:69], v[68:69], v[106:107]
    v_pk_mul_f32 v[70:71], v[70:71], v[106:107]
    v_cvt_pk_bf16_f32 v78, v68, v69
    v_cvt_pk_bf16_f32 v79, v70, v71
    s_waitcnt lgkmcnt(0)
    s_cmp_eq_u32 s76, 3
    s_cbranch_scc1 Q_NOEXP
    ds_write_b64 v249, v[84:85] offset:0
    ds_write_b64 v249, v[86:87] offset:512
    ds_write_b64 v249, v[88:89] offset:1024
    ds_write_b64 v249, v[174:175] offset:1536
    ds_write_b64 v249, v[182:183] offset:2048
Q_NOEXP:
    s_lshr_b32 s68, s76, 1
    s_mul_i32 s68, s68, 12288
    s_and_b32 s69, s76, 1
    s_mul_i32 s69, s69, 1536
    s_add_u32 s68, s68, s69
    v_lshl_add_u32 v249, v255, 3, s68
    s_movk_i32 s69, 512
    s_cmp_eq_u32 s76, 2
    s_cselect_b32 s69, 9728, s69
    s_cmp_eq_u32 s76, 0
    s_cselect_b32 s69, 0, s69
    v_subrev_u32 v166, s69, v249
    s_cmp_lg_u32 s77, 0
    s_cbranch_scc1 Q_NOVR
    v_pk_fma_f32 v[92:93], v[150:151], v[138:139], v[92:93] neg_lo:[1,0,0] neg_hi:[1,0,0]
    v_pk_fma_f32 v[94:95], v[152:153], v[138:139], v[94:95] neg_lo:[1,0,0] neg_hi:[1,0,0]
    v_pk_mul_f32 v[92:93], v[92:93], v[162:163]
    v_pk_mul_f32 v[94:95], v[94:95], v[164:165]
    v_cvt_pk_bf16_f32 v70, v92, v93
    v_cvt_pk_bf16_f32 v71, v94, v95
    ds_write_b64 v249, v[70:71] offset:1024
    v_pk_fma_f32 v[60:61], v[146:147], v[138:139], v[60:61] neg_lo:[1,0,0] neg_hi:[1,0,0]
    v_pk_fma_f32 v[62:63], v[148:149], v[138:139], v[62:63] neg_lo:[1,0,0] neg_hi:[1,0,0]
    v_pk_mul_f32 v[60:61], v[60:61], v[158:159]
    v_pk_mul_f32 v[62:63], v[62:63], v[160:161]
    v_cvt_pk_bf16_f32 v68, v60, v61
    v_cvt_pk_bf16_f32 v69, v62, v63
    ds_write_b64 v249, v[68:69] offset:512
    v_pk_fma_f32 v[28:29], v[142:143], v[138:139], v[28:29] neg_lo:[1,0,0] neg_hi:[1,0,0]
    v_pk_fma_f32 v[30:31], v[144:145], v[138:139], v[30:31] neg_lo:[1,0,0] neg_hi:[1,0,0]
    v_pk_mul_f32 v[28:29], v[28:29], v[154:155]
    v_pk_mul_f32 v[30:31], v[30:31], v[156:157]
    v_cvt_pk_bf16_f32 v66, v28, v29
    v_cvt_pk_bf16_f32 v67, v30, v31
    ds_write_b64 v249, v[66:67] offset:0
Q_NOVR:
    v_pk_fma_f32 v[52:53], v[146:147], v[130:131], v[52:53] neg_lo:[1,0,0] neg_hi:[1,0,0]
    v_pk_fma_f32 v[54:55], v[148:149], v[130:131], v[54:55] neg_lo:[1,0,0] neg_hi:[1,0,0]
    v_pk_mul_f32 v[52:53], v[52:53], v[158:159]
    v_pk_mul_f32 v[54:55], v[54:55], v[160:161]
    v_cvt_pk_bf16_f32 v172, v52, v53
    v_cvt_pk_bf16_f32 v173, v54, v55
    v_pk_fma_f32 v[56:57], v[146:147], v[132:133], v[56:57] neg_lo:[1,0,0] neg_hi:[1,0,0]
    v_pk_fma_f32 v[58:59], v[148:149], v[132:133], v[58:59] neg_lo:[1,0,0] neg_hi:[1,0,0]
    v_pk_mul_f32 v[56:57], v[56:57], v[158:159]
    v_pk_mul_f32 v[58:59], v[58:59], v[160:161]
    v_cvt_pk_bf16_f32 v180, v56, v57
    v_cvt_pk_bf16_f32 v181, v58, v59
    v_pk_fma_f32 v[40:41], v[100:101], v[118:119], v[40:41] neg_lo:[1,0,0] neg_hi:[1,0,0]
    v_pk_fma_f32 v[42:43], v[100:101], v[120:121], v[42:43] neg_lo:[1,0,0] neg_hi:[1,0,0]
    v_pk_mul_f32 v[40:41], v[40:41], v[102:103]
    v_pk_mul_f32 v[42:43], v[42:43], v[102:103]
    v_cvt_pk_bf16_f32 v52, v40, v41
    v_cvt_pk_bf16_f32 v53, v42, v43
    v_pk_fma_f32 v[44:45], v[100:101], v[122:123], v[44:45] neg_lo:[1,0,0] neg_hi:[1,0,0]
    v_pk_fma_f32 v[46:47], v[100:101], v[124:125], v[46:47] neg_lo:[1,0,0] neg_hi:[1,0,0]
    v_pk_mul_f32 v[44:45], v[44:45], v[102:103]
    v_pk_mul_f32 v[46:47], v[46:47], v[102:103]
    v_cvt_pk_bf16_f32 v56, v44, v45
    v_cvt_pk_bf16_f32 v57, v46, v47
    v_pk_fma_f32 v[48:49], v[100:101], v[126:127], v[48:49] neg_lo:[1,0,0] neg_hi:[1,0,0]
    v_pk_fma_f32 v[50:51], v[100:101], v[128:129], v[50:51] neg_lo:[1,0,0] neg_hi:[1,0,0]
    v_pk_mul_f32 v[48:49], v[48:49], v[102:103]
    v_pk_mul_f32 v[50:51], v[50:51], v[102:103]
    v_cvt_pk_bf16_f32 v140, v48, v49
    v_cvt_pk_bf16_f32 v141, v50, v51
    v_cndmask_b32 v42, 0, v140, s[72:73]
    v_cndmask_b32 v44, 0, v140, s[74:75]
    v_mov_b32 v54, v140
    v_cndmask_b32 v43, 0, v141, s[72:73]
    v_cndmask_b32 v45, 0, v141, s[74:75]
    v_mov_b32 v55, v141
    v_pk_fma_f32 v[32:33], v[100:101], v[110:111], v[32:33] neg_lo:[1,0,0] neg_hi:[1,0,0]
    v_pk_fma_f32 v[34:35], v[100:101], v[112:113], v[34:35] neg_lo:[1,0,0] neg_hi:[1,0,0]
    v_pk_mul_f32 v[32:33], v[32:33], v[102:103]
    v_pk_mul_f32 v[34:35], v[34:35], v[102:103]
    v_cvt_pk_bf16_f32 v40, v32, v33
    v_cvt_pk_bf16_f32 v41, v34, v35
    v_permlane32_swap_b32 v140, v54
    v_permlane32_swap_b32 v141, v55
    v_pk_fma_f32 v[36:37], v[100:101], v[114:115], v[36:37] neg_lo:[1,0,0] neg_hi:[1,0,0]
    v_pk_fma_f32 v[38:39], v[100:101], v[116:117], v[38:39] neg_lo:[1,0,0] neg_hi:[1,0,0]
    v_pk_mul_f32 v[36:37], v[36:37], v[102:103]
    v_pk_mul_f32 v[38:39], v[38:39], v[102:103]
    v_cvt_pk_bf16_f32 v46, v36, v37
    v_cvt_pk_bf16_f32 v47, v38, v39
    v_pk_fma_f32 v[20:21], v[142:143], v[130:131], v[20:21] neg_lo:[1,0,0] neg_hi:[1,0,0]
    v_pk_fma_f32 v[22:23], v[144:145], v[130:131], v[22:23] neg_lo:[1,0,0] neg_hi:[1,0,0]
    v_pk_mul_f32 v[20:21], v[20:21], v[154:155]
    v_pk_mul_f32 v[22:23], v[22:23], v[156:157]
    v_cvt_pk_bf16_f32 v170, v20, v21
    v_cvt_pk_bf16_f32 v171, v22, v23
    v_pk_fma_f32 v[24:25], v[142:143], v[132:133], v[24:25] neg_lo:[1,0,0] neg_hi:[1,0,0]
    v_pk_fma_f32 v[26:27], v[144:145], v[132:133], v[26:27] neg_lo:[1,0,0] neg_hi:[1,0,0]
    v_pk_mul_f32 v[24:25], v[24:25], v[154:155]
    v_pk_mul_f32 v[26:27], v[26:27], v[156:157]
    v_cvt_pk_bf16_f32 v178, v24, v25
    v_cvt_pk_bf16_f32 v179, v26, v27
    v_cvt_pk_bf16_f32 v20, v8, v9
    v_cvt_pk_bf16_f32 v21, v10, v11
    v_cvt_pk_bf16_f32 v24, v12, v13
    v_cvt_pk_bf16_f32 v25, v14, v15
    v_cvt_pk_bf16_f32 v140, v16, v17
    v_cvt_pk_bf16_f32 v141, v18, v19
    v_cndmask_b32 v10, 0, v140, s[72:73]
    v_cndmask_b32 v12, 0, v140, s[74:75]
    v_mov_b32 v22, v140
    v_cndmask_b32 v11, 0, v141, s[72:73]
    v_cndmask_b32 v13, 0, v141, s[74:75]
    v_mov_b32 v23, v141
    v_cvt_pk_bf16_f32 v8, v0, v1
    v_cvt_pk_bf16_f32 v9, v2, v3
    v_permlane32_swap_b32 v140, v22
    v_permlane32_swap_b32 v141, v23
    v_cvt_pk_bf16_f32 v14, v4, v5
    v_cvt_pk_bf16_f32 v15, v6, v7
    s_waitcnt lgkmcnt(0)
    s_barrier
    ds_read_b64 v[70:71], v249 offset:1024
    ds_read_b64 v[68:69], v249 offset:512
    ds_read_b64 v[66:67], v249 offset:0
    ds_read_b64 v[64:65], v166
    ds_read_b64 v[26:27], v248 offset:0
    ds_read_b64 v[28:29], v248 offset:512
    ds_read_b64 v[30:31], v248 offset:1024
    ds_read_b64 v[168:169], v248 offset:1536
    ds_read_b64 v[176:177], v248 offset:2048
    v_mov_b32 v32, 0
    v_mov_b32 v33, 0
    v_mov_b32 v34, 0
    v_mov_b32 v35, 0
    v_mov_b32 v36, 0
    v_mov_b32 v37, 0
    v_mov_b32 v38, 0
    v_mov_b32 v39, 0
    s_cmp_eq_u32 s77, 0
    s_cselect_b32 s72, 0xffff, 0
    s_cselect_b32 s73, 0, 0xffff
    s_mov_b32 s75, 0xffff0000
    v_mov_b32 v50, 0xff800000
    s_mov_b32 s84, 0xf000ff
    s_mov_b32 s85, 0xf000ff00
    s_mov_b32 s70, 0xf000000
    s_mov_b32 s71, 0xf0000
    v_cndmask_b32 v0, v50, 0, s[84:85]
    v_cndmask_b32 v4, v50, 0, s[70:71]
    v_mov_b32 v16, 0x3f803f80
    s_mov_b32 s84, 0xe000fe
    s_mov_b32 s85, 0xe000fe00
    s_mov_b32 s70, 0x1f000100
    s_mov_b32 s71, 0x1f0001
    v_cndmask_b32 v1, v50, 0, s[84:85]
    v_cndmask_b32 v5, v50, 0, s[70:71]
    v_mov_b32 v17, 0x3f803f80
    s_mov_b32 s84, 0xc000fc
    s_mov_b32 s85, 0xc000fc00
    s_mov_b32 s70, 0x3f000300
    s_mov_b32 s71, 0x3f0003
    v_cndmask_b32 v2, v50, 0, s[84:85]
    v_cndmask_b32 v6, v50, 0, s[70:71]
    v_mov_b32 v18, 0x3f803f80
    s_mov_b32 s84, 0x8000f8
    s_mov_b32 s85, 0x8000f800
    s_mov_b32 s70, 0x7f000700
    s_mov_b32 s71, 0x7f0007
    v_cndmask_b32 v3, v50, 0, s[84:85]
    v_cndmask_b32 v7, v50, 0, s[70:71]
    v_mov_b32 v19, 0x3f803f80
    s_add_u32 s88, s92, 3
    s_add_u32 s88, s88, s94
    s_mul_i32 s88, s88, 5120
    s_add_u32 s89, s88, 4096
    buffer_load_dwordx4 v[96:99], v254, s[52:55], s88 offen offset:0 sc1
    buffer_load_dwordx4 v[100:103], v254, s[52:55], s88 offen offset:1024 sc1
    buffer_load_dwordx4 v[104:107], v254, s[52:55], s88 offen offset:2048 sc1
    buffer_load_dwordx4 v[108:111], v254, s[52:55], s88 offen offset:3072 sc1
    buffer_load_dwordx4 v[112:115], v254, s[52:55], s89 offen sc1
    s_cmp_ge_u32 s99, 128
    s_cbranch_scc1 Q_SKIP2
    v_mfma_f32_16x16x32_bf16 v[136:139], v[84:87], v[72:75], v[0:3]
    v_mfma_f32_16x16x32_bf16 v[140:143], v[52:55], v[72:75], v[4:7]
    v_mfma_f32_16x16x32_bf16 v[144:147], v[86:89], v[76:79], v[0:3]
    v_mfma_f32_16x16x32_bf16 v[148:151], v[54:57], v[76:79], v[4:7]
    s_mul_i32 s68, s99, 75776
    s_add_u32 s69, s68, s87
    s_add_u32 s68, s68, s86
    s_nop 2
    v_max_f32 v136, v136, v140
    v_max_f32 v137, v137, v141
    v_max_f32 v138, v138, v142
    v_max_f32 v139, v139, v143
    v_max_f32 v144, v144, v148
    v_max_f32 v145, v145, v149
    v_max_f32 v146, v146, v150
    v_max_f32 v147, v147, v151
    v_max3_f32 v152, v136, v137, v138
    v_max3_f32 v154, v144, v145, v146
    v_max_f32 v152, v152, v139
    v_max_f32 v154, v154, v147
    s_nop 1
    v_permlane32_swap_b32 v152, v154
    v_max_f32 v152, v152, v154
    v_mov_b32 v154, v152
    s_nop 1
    v_permlane16_swap_b32 v152, v154
    v_max_f32 v152, v152, v154
    v_mul_f32 v152, 0xbea52b5c, v152
    v_mov_b32 v154, v152
    s_nop 1
    v_permlane32_swap_b32 v152, v154
    v_mov_b32 v153, v152
    v_mov_b32 v155, v154
    v_pk_fma_f32 v[136:137], v[136:137], s[82:83], v[152:153]
    v_pk_fma_f32 v[138:139], v[138:139], s[82:83], v[152:153]
    v_pk_fma_f32 v[144:145], v[144:145], s[82:83], v[154:155]
    v_pk_fma_f32 v[146:147], v[146:147], s[82:83], v[154:155]
    v_exp_f32 v136, v136
    v_exp_f32 v137, v137
    v_exp_f32 v138, v138
    v_exp_f32 v139, v139
    v_exp_f32 v144, v144
    v_exp_f32 v145, v145
    v_exp_f32 v146, v146
    v_exp_f32 v147, v147
    s_mov_b64 exec, s[80:81]
    v_cvt_pk_bf16_f32 v32, v136, v137
    v_cvt_pk_bf16_f32 v33, v138, v139
    v_cvt_pk_bf16_f32 v36, v144, v145
    v_cvt_pk_bf16_f32 v37, v146, v147
    s_mov_b64 exec, s[78:79]
    v_cvt_pk_bf16_f32 v34, v136, v137
    v_cvt_pk_bf16_f32 v35, v138, v139
    v_cvt_pk_bf16_f32 v38, v144, v145
    v_cvt_pk_bf16_f32 v39, v146, v147
    s_mov_b64 exec, -1
    s_waitcnt lgkmcnt(0)
    v_mfma_f32_16x16x32_bf16 v[136:139], v[16:19], v[32:35], 0
    v_mfma_f32_16x16x32_bf16 v[144:147], v[16:19], v[36:39], 0
    v_mfma_f32_16x16x32_bf16 v[152:155], v[172:175], v[32:35], 0
    v_mfma_f32_16x16x32_bf16 v[156:159], v[180:183], v[36:39], 0
    v_mfma_f32_16x16x32_bf16 v[160:163], v[68:71], v[32:35], 0
    v_mfma_f32_16x16x32_bf16 v[164:167], v[68:71], v[36:39], 0
    s_nop 2
    v_rcp_f32 v136, v136
    v_rcp_f32 v144, v144
    v_mov_b32 v137, v136
    v_mov_b32 v145, v144
    v_pk_mul_f32 v[152:153], v[152:153], v[136:137]
    v_pk_mul_f32 v[154:155], v[154:155], v[136:137]
    v_pk_mul_f32 v[156:157], v[156:157], v[144:145]
    v_pk_mul_f32 v[158:159], v[158:159], v[144:145]
    v_pk_mul_f32 v[160:161], v[160:161], v[136:137]
    v_pk_mul_f32 v[162:163], v[162:163], v[136:137]
    s_mov_b64 exec, s[74:75]
    v_pk_mul_f32 v[160:161], v[164:165], v[144:145]
    v_pk_mul_f32 v[162:163], v[166:167], v[144:145]
    s_mov_b64 exec, -1
    v_cvt_pk_bf16_f32 v76, v160, v161
    v_cvt_pk_bf16_f32 v77, v162, v163
    v_cvt_pk_bf16_f32 v72, v152, v153
    v_cvt_pk_bf16_f32 v74, v156, v157
    v_cvt_pk_bf16_f32 v73, v154, v155
    v_cvt_pk_bf16_f32 v75, v158, v159
    v_permlane16_swap_b32 v76, v78
    v_permlane16_swap_b32 v77, v79
    buffer_store_dwordx4 v[72:75], v244, s[36:39], s68 offen sc1
    s_mov_b64 exec, s[72:73]
    buffer_store_dwordx4 v[76:79], v246, s[36:39], s69 offen sc1
    s_mov_b64 exec, -1
Q_SKIP2:
    s_cmp_ge_u32 s98, 128
    s_cbranch_scc1 Q_SKIP1
    s_cmp_eq_u32 s98, 0
    s_cbranch_scc0 SK_46
    v_mov_b32 v4, v50
    v_mov_b32 v5, v50
    v_mov_b32 v6, v50
    v_mov_b32 v7, v50
SK_46:
    v_mfma_f32_16x16x32_bf16 v[136:139], v[52:55], v[40:43], v[0:3]
    s_nop 0
    v_mfma_f32_16x16x32_bf16 v[140:143], v[20:23], v[40:43], v[4:7]
    v_mfma_f32_16x16x32_bf16 v[144:147], v[54:57], v[44:47], v[0:3]
    v_mfma_f32_16x16x32_bf16 v[148:151], v[22:25], v[44:47], v[4:7]
    s_mul_i32 s68, s98, 75776
    s_add_u32 s69, s68, s87
    s_add_u32 s68, s68, s86
    s_nop 2
    v_max_f32 v136, v136, v140
    v_max_f32 v137, v137, v141
    v_max_f32 v138, v138, v142
    v_max_f32 v139, v139, v143
    v_max_f32 v144, v144, v148
    v_max_f32 v145, v145, v149
    v_max_f32 v146, v146, v150
    v_max_f32 v147, v147, v151
    v_max3_f32 v152, v136, v137, v138
    v_max3_f32 v154, v144, v145, v146
    v_max_f32 v152, v152, v139
    v_max_f32 v154, v154, v147
    s_nop 1
    v_permlane32_swap_b32 v152, v154
    v_max_f32 v152, v152, v154
    v_mov_b32 v154, v152
    s_nop 1
    v_permlane16_swap_b32 v152, v154
    v_max_f32 v152, v152, v154
    v_mul_f32 v152, 0xbea52b5c, v152
    v_mov_b32 v154, v152
    s_nop 1
    v_permlane32_swap_b32 v152, v154
    v_mov_b32 v153, v152
    v_mov_b32 v155, v154
    v_pk_fma_f32 v[136:137], v[136:137], s[82:83], v[152:153]
    v_pk_fma_f32 v[138:139], v[138:139], s[82:83], v[152:153]
    v_pk_fma_f32 v[144:145], v[144:145], s[82:83], v[154:155]
    v_pk_fma_f32 v[146:147], v[146:147], s[82:83], v[154:155]
    v_exp_f32 v136, v136
    v_exp_f32 v137, v137
    v_exp_f32 v138, v138
    v_exp_f32 v139, v139
    v_exp_f32 v144, v144
    v_exp_f32 v145, v145
    v_exp_f32 v146, v146
    v_exp_f32 v147, v147
    s_mov_b64 exec, s[80:81]
    v_cvt_pk_bf16_f32 v32, v136, v137
    v_cvt_pk_bf16_f32 v33, v138, v139
    v_cvt_pk_bf16_f32 v36, v144, v145
    v_cvt_pk_bf16_f32 v37, v146, v147
    s_mov_b64 exec, s[78:79]
    v_cvt_pk_bf16_f32 v34, v136, v137
    v_cvt_pk_bf16_f32 v35, v138, v139
    v_cvt_pk_bf16_f32 v38, v144, v145
    v_cvt_pk_bf16_f32 v39, v146, v147
    s_mov_b64 exec, -1
    s_waitcnt lgkmcnt(0)
    v_mfma_f32_16x16x32_bf16 v[136:139], v[16:19], v[32:35], 0
    v_mfma_f32_16x16x32_bf16 v[144:147], v[16:19], v[36:39], 0
    v_mfma_f32_16x16x32_bf16 v[152:155], v[170:173], v[32:35], 0
    v_mfma_f32_16x16x32_bf16 v[156:159], v[178:181], v[36:39], 0
    v_mfma_f32_16x16x32_bf16 v[160:163], v[66:69], v[32:35], 0
    v_mfma_f32_16x16x32_bf16 v[164:167], v[66:69], v[36:39], 0
    s_nop 2
    v_rcp_f32 v136, v136
    v_rcp_f32 v144, v144
    v_mov_b32 v137, v136
    v_mov_b32 v145, v144
    v_pk_mul_f32 v[152:153], v[152:153], v[136:137]
    v_pk_mul_f32 v[154:155], v[154:155], v[136:137]
    v_pk_mul_f32 v[156:157], v[156:157], v[144:145]
    v_pk_mul_f32 v[158:159], v[158:159], v[144:145]
    v_pk_mul_f32 v[160:161], v[160:161], v[136:137]
    v_pk_mul_f32 v[162:163], v[162:163], v[136:137]
    s_mov_b64 exec, s[74:75]
    v_pk_mul_f32 v[160:161], v[164:165], v[144:145]
    v_pk_mul_f32 v[162:163], v[166:167], v[144:145]
    s_mov_b64 exec, -1
    v_cvt_pk_bf16_f32 v44, v160, v161
    v_cvt_pk_bf16_f32 v45, v162, v163
    v_cvt_pk_bf16_f32 v40, v152, v153
    v_cvt_pk_bf16_f32 v42, v156, v157
    v_cvt_pk_bf16_f32 v41, v154, v155
    v_cvt_pk_bf16_f32 v43, v158, v159
    v_permlane16_swap_b32 v44, v46
    v_permlane16_swap_b32 v45, v47
    buffer_store_dwordx4 v[40:43], v245, s[36:39], s68 offen sc1
    s_mov_b64 exec, s[72:73]
    buffer_store_dwordx4 v[44:47], v247, s[36:39], s69 offen sc1
    s_mov_b64 exec, -1
Q_SKIP1:
    s_cmp_ge_u32 s97, 128
    s_cbranch_scc1 Q_SKIP0
    s_cmp_eq_u32 s76, 0
    s_cbranch_scc1 Q_SKIP0
    s_waitcnt lgkmcnt(0)
    v_mfma_f32_16x16x32_bf16 v[136:139], v[20:23], v[8:11], v[0:3]
    v_mfma_f32_16x16x32_bf16 v[140:143], v[26:29], v[8:11], v[4:7]
    v_mfma_f32_16x16x32_bf16 v[144:147], v[22:25], v[12:15], v[0:3]
    v_mfma_f32_16x16x32_bf16 v[148:151], v[28:31], v[12:15], v[4:7]
    s_mul_i32 s68, s97, 75776
    s_add_u32 s69, s68, s87
    s_add_u32 s68, s68, s86
    s_nop 2
    v_max_f32 v136, v136, v140
    v_max_f32 v137, v137, v141
    v_max_f32 v138, v138, v142
    v_max_f32 v139, v139, v143
    v_max_f32 v144, v144, v148
    v_max_f32 v145, v145, v149
    v_max_f32 v146, v146, v150
    v_max_f32 v147, v147, v151
    v_max3_f32 v152, v136, v137, v138
    v_max3_f32 v154, v144, v145, v146
    v_max_f32 v152, v152, v139
    v_max_f32 v154, v154, v147
    s_nop 1
    v_permlane32_swap_b32 v152, v154
    v_max_f32 v152, v152, v154
    v_mov_b32 v154, v152
    s_nop 1
    v_permlane16_swap_b32 v152, v154
    v_max_f32 v152, v152, v154
    v_mul_f32 v152, 0xbea52b5c, v152
    v_mov_b32 v154, v152
    s_nop 1
    v_permlane32_swap_b32 v152, v154
    v_mov_b32 v153, v152
    v_mov_b32 v155, v154
    v_pk_fma_f32 v[136:137], v[136:137], s[82:83], v[152:153]
    v_pk_fma_f32 v[138:139], v[138:139], s[82:83], v[152:153]
    v_pk_fma_f32 v[144:145], v[144:145], s[82:83], v[154:155]
    v_pk_fma_f32 v[146:147], v[146:147], s[82:83], v[154:155]
    v_exp_f32 v136, v136
    v_exp_f32 v137, v137
    v_exp_f32 v138, v138
    v_exp_f32 v139, v139
    v_exp_f32 v144, v144
    v_exp_f32 v145, v145
    v_exp_f32 v146, v146
    v_exp_f32 v147, v147
    s_mov_b64 exec, s[80:81]
    v_cvt_pk_bf16_f32 v32, v136, v137
    v_cvt_pk_bf16_f32 v33, v138, v139
    v_cvt_pk_bf16_f32 v36, v144, v145
    v_cvt_pk_bf16_f32 v37, v146, v147
    s_mov_b64 exec, s[78:79]
    v_cvt_pk_bf16_f32 v34, v136, v137
    v_cvt_pk_bf16_f32 v35, v138, v139
    v_cvt_pk_bf16_f32 v38, v144, v145
    v_cvt_pk_bf16_f32 v39, v146, v147
    s_mov_b64 exec, -1
    s_waitcnt lgkmcnt(0)
    v_mfma_f32_16x16x32_bf16 v[136:139], v[16:19], v[32:35], 0
    v_mfma_f32_16x16x32_bf16 v[144:147], v[16:19], v[36:39], 0
    v_mfma_f32_16x16x32_bf16 v[152:155], v[168:171], v[32:35], 0
    v_mfma_f32_16x16x32_bf16 v[156:159], v[176:179], v[36:39], 0
    v_mfma_f32_16x16x32_bf16 v[160:163], v[64:67], v[32:35], 0
    v_mfma_f32_16x16x32_bf16 v[164:167], v[64:67], v[36:39], 0
    s_nop 2
    v_rcp_f32 v136, v136
    v_rcp_f32 v144, v144
    v_mov_b32 v137, v136
    v_mov_b32 v145, v144
    v_pk_mul_f32 v[152:153], v[152:153], v[136:137]
    v_pk_mul_f32 v[154:155], v[154:155], v[136:137]
    v_pk_mul_f32 v[156:157], v[156:157], v[144:145]
    v_pk_mul_f32 v[158:159], v[158:159], v[144:145]
    v_pk_mul_f32 v[160:161], v[160:161], v[136:137]
    v_pk_mul_f32 v[162:163], v[162:163], v[136:137]
    s_mov_b64 exec, s[74:75]
    v_pk_mul_f32 v[160:161], v[164:165], v[144:145]
    v_pk_mul_f32 v[162:163], v[166:167], v[144:145]
    s_mov_b64 exec, -1
    v_cvt_pk_bf16_f32 v12, v160, v161
    v_cvt_pk_bf16_f32 v13, v162, v163
    v_cvt_pk_bf16_f32 v8, v152, v153
    v_cvt_pk_bf16_f32 v10, v156, v157
    v_cvt_pk_bf16_f32 v9, v154, v155
    v_cvt_pk_bf16_f32 v11, v158, v159
    v_permlane16_swap_b32 v12, v14
    v_permlane16_swap_b32 v13, v15
    buffer_store_dwordx4 v[8:11], v244, s[36:39], s68 offen sc1
    s_mov_b64 exec, s[72:73]
    buffer_store_dwordx4 v[12:15], v246, s[36:39], s69 offen sc1
    s_mov_b64 exec, -1
Q_SKIP0:
    s_add_u32 s88, s92, 4
    s_add_u32 s88, s88, s94
    s_mul_i32 s88, s88, 5120
    s_add_u32 s89, s88, 4096
    buffer_load_dwordx4 v[116:119], v254, s[52:55], s88 offen offset:0 sc1
    buffer_load_dwordx4 v[120:123], v254, s[52:55], s88 offen offset:1024 sc1
    buffer_load_dwordx4 v[124:127], v254, s[52:55], s88 offen offset:2048 sc1
    buffer_load_dwordx4 v[128:131], v254, s[52:55], s88 offen offset:3072 sc1
    buffer_load_dwordx4 v[132:135], v254, s[52:55], s89 offen sc1
    s_cmp_lg_u32 s40, 0
    s_cbranch_scc1 HQ_OK
    v_mov_b32 v252, 0
    s_mov_b32 s3, 0
HQ_CHK:
    s_mov_b64 exec, -1
    v_cmp_le_u32 vcc, 14, v252
    s_nop 0
    s_and_b32 s68, vcc_lo, 3
    s_cmp_eq_u32 s68, 3
    s_cbranch_scc1 HQ_OK
    s_add_u32 s3, s3, 1
    s_cmp_gt_u32 s3, 2097152
    s_cbranch_scc1 HQ_OK
    s_sleep 1
    s_mov_b64 exec, 15
    buffer_load_dword v252, v250, s[60:63], 0 offen sc1
    s_waitcnt vmcnt(0)
    s_branch HQ_CHK
HQ_OK:
    s_waitcnt lgkmcnt(0)
    s_barrier
    s_branch P2_ENTRY
P2_ENTRY:
    s_cmp_ge_u32 s2, 96
    s_cbranch_scc0 SK_47
    s_add_u32 s88, s92, 3
    s_add_u32 s88, s88, s94
    s_mul_i32 s88, s88, 5120
    s_add_u32 s89, s88, 4096
    buffer_load_dwordx4 v[96:99], v254, s[52:55], s88 offen offset:0 sc1
    buffer_load_dwordx4 v[100:103], v254, s[52:55], s88 offen offset:1024 sc1
    buffer_load_dwordx4 v[104:107], v254, s[52:55], s88 offen offset:2048 sc1
    buffer_load_dwordx4 v[108:111], v254, s[52:55], s88 offen offset:3072 sc1
    buffer_load_dwordx4 v[112:115], v254, s[52:55], s89 offen sc1
    s_add_u32 s88, s92, 4
    s_add_u32 s88, s88, s94
    s_mul_i32 s88, s88, 5120
    s_add_u32 s89, s88, 4096
    buffer_load_dwordx4 v[116:119], v254, s[52:55], s88 offen offset:0 sc1
    buffer_load_dwordx4 v[120:123], v254, s[52:55], s88 offen offset:1024 sc1
    buffer_load_dwordx4 v[124:127], v254, s[52:55], s88 offen offset:2048 sc1
    buffer_load_dwordx4 v[128:131], v254, s[52:55], s88 offen offset:3072 sc1
    buffer_load_dwordx4 v[132:135], v254, s[52:55], s89 offen sc1
SK_47:
    s_add_u32 s45, s45, 1024
    s_add_u32 m0, s49, 0
    s_nop 0
    buffer_load_dwordx4 v254, s[52:55], s45 offen sc1 lds
    s_add_u32 s45, s45, 1024
    s_add_u32 m0, s49, 8192
    s_nop 0
    buffer_load_dwordx4 v254, s[52:55], s45 offen sc1 lds
    s_add_u32 s45, s45, 1024
    s_add_u32 m0, s49, 16384
    s_nop 0
    buffer_load_dwordx4 v254, s[52:55], s45 offen sc1 lds
    s_add_u32 s45, s45, 1024
    s_add_u32 m0, s49, 155648
    s_nop 0
    buffer_load_dwordx4 v254, s[52:55], s45 offen sc1 lds
    v_and_b32 v244, 12, v255
    v_lshlrev_b32 v244, 6, v244
    v_and_b32 v245, 48, v255
    v_lshl_add_u32 v244, v245, 2, v244
    v_and_b32 v245, 3, v255
    v_lshl_add_u32 v244, v245, 4, v244
    s_add_u32 s68, s40, 3
    s_and_b32 s68, s68, 3
    s_mul_i32 s68, s68, 75776
    v_add_u32 v247, s68, v244
    s_add_u32 s68, s40, 2
    s_and_b32 s68, s68, 3
    s_mul_i32 s68, s68, 75776
    v_add_u32 v246, s68, v244
    s_add_u32 s68, s40, 1
    s_and_b32 s68, s68, 3
    s_mul_i32 s68, s68, 75776
    v_add_u32 v245, s68, v244
    s_add_u32 s68, s40, 0
    s_and_b32 s68, s68, 3
    s_mul_i32 s68, s68, 75776
    v_add_u32 v244, s68, v244
    s_mul_i32 s76, s90, 303104
    v_add_u32 v248, s49, v254
    v_add_u32 v249, 65536, v248
    v_add_u32 v253, 131072, v248
    s_cmp_lt_u32 s2, 96
    s_cbranch_scc1 P2_GO
    s_cmp_lg_u32 s40, 3
    s_cbranch_scc1 HS_OK
    s_mov_b32 s3, 0
HS_CHK:
    s_mov_b64 exec, -1
    v_cmp_le_u32 vcc, 14, v252
    s_nop 0
    s_and_b32 s68, vcc_lo, 3
    s_cmp_eq_u32 s68, 3
    s_cbranch_scc1 HS_OK
    s_add_u32 s3, s3, 1
    s_cmp_gt_u32 s3, 2097152
    s_cbranch_scc1 HS_OK
    s_sleep 2
    s_mov_b64 exec, 15
    buffer_load_dword v252, v250, s[60:63], 0 offen sc1
    s_waitcnt vmcnt(0)
    s_branch HS_CHK
HS_OK:
    s_barrier
P2_GO:
    s_cmp_ge_u32 s40, 4
    s_cbranch_scc1 P2_YOUNG
    s_add_u32 s68, s92, 0
    s_lshl_b32 s68, s68, 10
    s_add_u32 s68, s68, s76
    buffer_load_dwordx4 v[80:83], v244, s[36:39], s68 offen sc1
    buffer_load_dwordx4 v[84:87], v245, s[36:39], s68 offen sc1
    buffer_load_dwordx4 v[88:91], v246, s[36:39], s68 offen sc1
    buffer_load_dwordx4 v[92:95], v247, s[36:39], s68 offen sc1
    s_add_u32 s68, s92, 1
    s_lshl_b32 s68, s68, 10
    s_add_u32 s68, s68, s76
    buffer_load_dwordx4 v[136:139], v244, s[36:39], s68 offen sc1
    buffer_load_dwordx4 v[140:143], v245, s[36:39], s68 offen sc1
    buffer_load_dwordx4 v[144:147], v246, s[36:39], s68 offen sc1
    buffer_load_dwordx4 v[148:151], v247, s[36:39], s68 offen sc1
    s_barrier
    s_add_u32 s68, s92, 2
    s_lshl_b32 s68, s68, 10
    s_add_u32 s68, s68, s76
    buffer_load_dwordx4 v[152:155], v244, s[36:39], s68 offen sc1
    buffer_load_dwordx4 v[156:159], v245, s[36:39], s68 offen sc1
    buffer_load_dwordx4 v[160:163], v246, s[36:39], s68 offen sc1
    buffer_load_dwordx4 v[164:167], v247, s[36:39], s68 offen sc1
    s_waitcnt vmcnt(16)
    s_barrier
    s_waitcnt vmcnt(11)
    v_mfma_f32_16x16x32_bf16 v[0:3], v[184:187], v[80:83], 0
    v_mfma_f32_16x16x32_bf16 v[4:7], v[188:191], v[80:83], 0
    v_mfma_f32_16x16x32_bf16 v[8:11], v[192:195], v[80:83], 0
    v_mfma_f32_16x16x32_bf16 v[12:15], v[196:199], v[80:83], 0
    v_mfma_f32_16x16x32_bf16 v[16:19], v[200:203], v[80:83], 0
    s_waitcnt vmcnt(10)
    v_mfma_f32_16x16x32_bf16 v[20:23], v[184:187], v[84:87], 0
    v_mfma_f32_16x16x32_bf16 v[24:27], v[188:191], v[84:87], 0
    v_mfma_f32_16x16x32_bf16 v[28:31], v[192:195], v[84:87], 0
    v_mfma_f32_16x16x32_bf16 v[32:35], v[196:199], v[84:87], 0
    v_mfma_f32_16x16x32_bf16 v[36:39], v[200:203], v[84:87], 0
    s_waitcnt vmcnt(9)
    v_mfma_f32_16x16x32_bf16 v[40:43], v[184:187], v[88:91], 0
    v_mfma_f32_16x16x32_bf16 v[44:47], v[188:191], v[88:91], 0
    v_mfma_f32_16x16x32_bf16 v[48:51], v[192:195], v[88:91], 0
    v_mfma_f32_16x16x32_bf16 v[52:55], v[196:199], v[88:91], 0
    v_mfma_f32_16x16x32_bf16 v[56:59], v[200:203], v[88:91], 0
    s_waitcnt vmcnt(8)
    v_mfma_f32_16x16x32_bf16 v[60:63], v[184:187], v[92:95], 0
    v_mfma_f32_16x16x32_bf16 v[64:67], v[188:191], v[92:95], 0
    v_mfma_f32_16x16x32_bf16 v[68:71], v[192:195], v[92:95], 0
    v_mfma_f32_16x16x32_bf16 v[72:75], v[196:199], v[92:95], 0
    v_mfma_f32_16x16x32_bf16 v[76:79], v[200:203], v[92:95], 0
    s_waitcnt vmcnt(7)
    v_mfma_f32_16x16x32_bf16 v[0:3], v[204:207], v[136:139], v[0:3]
    v_mfma_f32_16x16x32_bf16 v[4:7], v[208:211], v[136:139], v[4:7]
    v_mfma_f32_16x16x32_bf16 v[8:11], v[212:215], v[136:139], v[8:11]
    v_mfma_f32_16x16x32_bf16 v[12:15], v[216:219], v[136:139], v[12:15]
    v_mfma_f32_16x16x32_bf16 v[16:19], v[220:223], v[136:139], v[16:19]
    s_waitcnt vmcnt(6)
    v_mfma_f32_16x16x32_bf16 v[20:23], v[204:207], v[140:143], v[20:23]
    v_mfma_f32_16x16x32_bf16 v[24:27], v[208:211], v[140:143], v[24:27]
    v_mfma_f32_16x16x32_bf16 v[28:31], v[212:215], v[140:143], v[28:31]
    v_mfma_f32_16x16x32_bf16 v[32:35], v[216:219], v[140:143], v[32:35]
    v_mfma_f32_16x16x32_bf16 v[36:39], v[220:223], v[140:143], v[36:39]
    s_waitcnt vmcnt(5)
    v_mfma_f32_16x16x32_bf16 v[40:43], v[204:207], v[144:147], v[40:43]
    v_mfma_f32_16x16x32_bf16 v[44:47], v[208:211], v[144:147], v[44:47]
    v_mfma_f32_16x16x32_bf16 v[48:51], v[212:215], v[144:147], v[48:51]
    v_mfma_f32_16x16x32_bf16 v[52:55], v[216:219], v[144:147], v[52:55]
    v_mfma_f32_16x16x32_bf16 v[56:59], v[220:223], v[144:147], v[56:59]
    s_waitcnt vmcnt(4)
    v_mfma_f32_16x16x32_bf16 v[60:63], v[204:207], v[148:151], v[60:63]
    v_mfma_f32_16x16x32_bf16 v[64:67], v[208:211], v[148:151], v[64:67]
    v_mfma_f32_16x16x32_bf16 v[68:71], v[212:215], v[148:151], v[68:71]
    v_mfma_f32_16x16x32_bf16 v[72:75], v[216:219], v[148:151], v[72:75]
    v_mfma_f32_16x16x32_bf16 v[76:79], v[220:223], v[148:151], v[76:79]
    s_barrier
    s_add_u32 s68, s92, 3
    s_lshl_b32 s68, s68, 10
    s_add_u32 s68, s68, s76
    buffer_load_dwordx4 v[168:171], v244, s[36:39], s68 offen sc1
    buffer_load_dwordx4 v[172:175], v245, s[36:39], s68 offen sc1
    buffer_load_dwordx4 v[176:179], v246, s[36:39], s68 offen sc1
    buffer_load_dwordx4 v[180:183], v247, s[36:39], s68 offen sc1
    s_add_u32 s68, s92, 4
    s_lshl_b32 s68, s68, 10
    s_add_u32 s68, s68, s76
    buffer_load_dwordx4 v[80:83], v244, s[36:39], s68 offen sc1
    buffer_load_dwordx4 v[84:87], v245, s[36:39], s68 offen sc1
    buffer_load_dwordx4 v[88:91], v246, s[36:39], s68 offen sc1
    buffer_load_dwordx4 v[92:95], v247, s[36:39], s68 offen sc1
    ds_read_b128 v[184:187], v248 offset:24576
    ds_read_b128 v[188:191], v248 offset:32768
    ds_read_b128 v[192:195], v248 offset:40960
    ds_read_b128 v[196:199], v248 offset:49152
    ds_read_b128 v[200:203], v248 offset:57344
    ds_read_b128 v[204:207], v249 offset:0
    ds_read_b128 v[208:211], v248 offset:0
    ds_read_b128 v[212:215], v248 offset:8192
    ds_read_b128 v[216:219], v248 offset:16384
    ds_read_b128 v[220:223], v253 offset:24576
    s_barrier
    s_waitcnt vmcnt(11)
    v_mfma_f32_16x16x32_bf16 v[0:3], v[224:227], v[152:155], v[0:3]
    v_mfma_f32_16x16x32_bf16 v[4:7], v[228:231], v[152:155], v[4:7]
    v_mfma_f32_16x16x32_bf16 v[8:11], v[232:235], v[152:155], v[8:11]
    v_mfma_f32_16x16x32_bf16 v[12:15], v[236:239], v[152:155], v[12:15]
    v_mfma_f32_16x16x32_bf16 v[16:19], v[240:243], v[152:155], v[16:19]
    s_waitcnt vmcnt(10)
    v_mfma_f32_16x16x32_bf16 v[20:23], v[224:227], v[156:159], v[20:23]
    v_mfma_f32_16x16x32_bf16 v[24:27], v[228:231], v[156:159], v[24:27]
    v_mfma_f32_16x16x32_bf16 v[28:31], v[232:235], v[156:159], v[28:31]
    v_mfma_f32_16x16x32_bf16 v[32:35], v[236:239], v[156:159], v[32:35]
    v_mfma_f32_16x16x32_bf16 v[36:39], v[240:243], v[156:159], v[36:39]
    s_waitcnt vmcnt(9)
    v_mfma_f32_16x16x32_bf16 v[40:43], v[224:227], v[160:163], v[40:43]
    v_mfma_f32_16x16x32_bf16 v[44:47], v[228:231], v[160:163], v[44:47]
    v_mfma_f32_16x16x32_bf16 v[48:51], v[232:235], v[160:163], v[48:51]
    v_mfma_f32_16x16x32_bf16 v[52:55], v[236:239], v[160:163], v[52:55]
    v_mfma_f32_16x16x32_bf16 v[56:59], v[240:243], v[160:163], v[56:59]
    s_waitcnt vmcnt(8)
    v_mfma_f32_16x16x32_bf16 v[60:63], v[224:227], v[164:167], v[60:63]
    v_mfma_f32_16x16x32_bf16 v[64:67], v[228:231], v[164:167], v[64:67]
    v_mfma_f32_16x16x32_bf16 v[68:71], v[232:235], v[164:167], v[68:71]
    v_mfma_f32_16x16x32_bf16 v[72:75], v[236:239], v[164:167], v[72:75]
    v_mfma_f32_16x16x32_bf16 v[76:79], v[240:243], v[164:167], v[76:79]
    s_waitcnt vmcnt(7)
    v_mfma_f32_16x16x32_bf16 v[0:3], v[96:99], v[168:171], v[0:3]
    v_mfma_f32_16x16x32_bf16 v[4:7], v[100:103], v[168:171], v[4:7]
    v_mfma_f32_16x16x32_bf16 v[8:11], v[104:107], v[168:171], v[8:11]
    v_mfma_f32_16x16x32_bf16 v[12:15], v[108:111], v[168:171], v[12:15]
    v_mfma_f32_16x16x32_bf16 v[16:19], v[112:115], v[168:171], v[16:19]
    s_waitcnt vmcnt(6)
    v_mfma_f32_16x16x32_bf16 v[20:23], v[96:99], v[172:175], v[20:23]
    v_mfma_f32_16x16x32_bf16 v[24:27], v[100:103], v[172:175], v[24:27]
    v_mfma_f32_16x16x32_bf16 v[28:31], v[104:107], v[172:175], v[28:31]
    v_mfma_f32_16x16x32_bf16 v[32:35], v[108:111], v[172:175], v[32:35]
    v_mfma_f32_16x16x32_bf16 v[36:39], v[112:115], v[172:175], v[36:39]
    s_waitcnt vmcnt(5)
    v_mfma_f32_16x16x32_bf16 v[40:43], v[96:99], v[176:179], v[40:43]
    v_mfma_f32_16x16x32_bf16 v[44:47], v[100:103], v[176:179], v[44:47]
    v_mfma_f32_16x16x32_bf16 v[48:51], v[104:107], v[176:179], v[48:51]
    v_mfma_f32_16x16x32_bf16 v[52:55], v[108:111], v[176:179], v[52:55]
    v_mfma_f32_16x16x32_bf16 v[56:59], v[112:115], v[176:179], v[56:59]
    s_waitcnt vmcnt(4)
    v_mfma_f32_16x16x32_bf16 v[60:63], v[96:99], v[180:183], v[60:63]
    v_mfma_f32_16x16x32_bf16 v[64:67], v[100:103], v[180:183], v[64:67]
    v_mfma_f32_16x16x32_bf16 v[68:71], v[104:107], v[180:183], v[68:71]
    v_mfma_f32_16x16x32_bf16 v[72:75], v[108:111], v[180:183], v[72:75]
    v_mfma_f32_16x16x32_bf16 v[76:79], v[112:115], v[180:183], v[76:79]
    s_cmp_eq_u32 s40, 0
    s_cbranch_scc0 SK_48
    s_mov_b64 exec, 15
    buffer_load_dword v252, v250, s[60:63], 0 offen sc1
    s_mov_b64 exec, -1
SK_48:
    s_add_u32 s68, s92, 5
    s_lshl_b32 s68, s68, 10
    s_add_u32 s68, s68, s76
    buffer_load_dwordx4 v[136:139], v244, s[36:39], s68 offen sc1
    buffer_load_dwordx4 v[140:143], v245, s[36:39], s68 offen sc1
    buffer_load_dwordx4 v[144:147], v246, s[36:39], s68 offen sc1
    buffer_load_dwordx4 v[148:151], v247, s[36:39], s68 offen sc1
    s_mov_b32 s68, s95
    s_lshl_b32 s68, s68, 10
    s_add_u32 s68, s68, s76
    buffer_load_dwordx4 v[152:155], v244, s[36:39], s68 offen sc1
    buffer_load_dwordx4 v[156:159], v245, s[36:39], s68 offen sc1
    buffer_load_dwordx4 v[160:163], v246, s[36:39], s68 offen sc1
    buffer_load_dwordx4 v[164:167], v247, s[36:39], s68 offen sc1
    ds_read_b128 v[224:227], v249 offset:8192
    ds_read_b128 v[228:231], v249 offset:16384
    ds_read_b128 v[232:235], v249 offset:24576
    ds_read_b128 v[236:239], v249 offset:32768
    ds_read_b128 v[240:243], v249 offset:40960
    ds_read_b128 v[96:99], v249 offset:49152
    ds_read_b128 v[100:103], v249 offset:57344
    ds_read_b128 v[104:107], v253 offset:0
    ds_read_b128 v[108:111], v253 offset:8192
    ds_read_b128 v[112:115], v253 offset:16384
    s_cmp_lg_u32 s40, 0
    s_cbranch_scc1 OS1_OK
    s_waitcnt vmcnt(8)
    s_mov_b32 s3, 0
OS1_CHK:
    s_mov_b64 exec, -1
    v_cmp_le_u32 vcc, 8, v252
    s_nop 0
    s_and_b32 s68, vcc_lo, 12
    s_cmp_eq_u32 s68, 12
    s_cbranch_scc1 OS1_OK
    s_add_u32 s3, s3, 1
    s_cmp_gt_u32 s3, 2097152
    s_cbranch_scc1 OS1_OK
    s_sleep 2
    s_mov_b64 exec, 15
    buffer_load_dword v252, v250, s[60:63], 0 offen sc1
    s_waitcnt vmcnt(0)
    s_branch OS1_CHK
OS1_OK:
    s_barrier
    s_waitcnt vmcnt(11)
    v_mfma_f32_16x16x32_bf16 v[0:3], v[116:119], v[80:83], v[0:3]
    v_mfma_f32_16x16x32_bf16 v[4:7], v[120:123], v[80:83], v[4:7]
    v_mfma_f32_16x16x32_bf16 v[8:11], v[124:127], v[80:83], v[8:11]
    v_mfma_f32_16x16x32_bf16 v[12:15], v[128:131], v[80:83], v[12:15]
    v_mfma_f32_16x16x32_bf16 v[16:19], v[132:135], v[80:83], v[16:19]
    s_waitcnt vmcnt(10)
    v_mfma_f32_16x16x32_bf16 v[20:23], v[116:119], v[84:87], v[20:23]
    v_mfma_f32_16x16x32_bf16 v[24:27], v[120:123], v[84:87], v[24:27]
    v_mfma_f32_16x16x32_bf16 v[28:31], v[124:127], v[84:87], v[28:31]
    v_mfma_f32_16x16x32_bf16 v[32:35], v[128:131], v[84:87], v[32:35]
    v_mfma_f32_16x16x32_bf16 v[36:39], v[132:135], v[84:87], v[36:39]
    s_waitcnt vmcnt(9)
    v_mfma_f32_16x16x32_bf16 v[40:43], v[116:119], v[88:91], v[40:43]
    v_mfma_f32_16x16x32_bf16 v[44:47], v[120:123], v[88:91], v[44:47]
    v_mfma_f32_16x16x32_bf16 v[48:51], v[124:127], v[88:91], v[48:51]
    v_mfma_f32_16x16x32_bf16 v[52:55], v[128:131], v[88:91], v[52:55]
    v_mfma_f32_16x16x32_bf16 v[56:59], v[132:135], v[88:91], v[56:59]
    s_waitcnt vmcnt(8)
    v_mfma_f32_16x16x32_bf16 v[60:63], v[116:119], v[92:95], v[60:63]
    v_mfma_f32_16x16x32_bf16 v[64:67], v[120:123], v[92:95], v[64:67]
    v_mfma_f32_16x16x32_bf16 v[68:71], v[124:127], v[92:95], v[68:71]
    v_mfma_f32_16x16x32_bf16 v[72:75], v[128:131], v[92:95], v[72:75]
    v_mfma_f32_16x16x32_bf16 v[76:79], v[132:135], v[92:95], v[76:79]
    s_waitcnt vmcnt(7) lgkmcnt(0)
    v_mfma_f32_16x16x32_bf16 v[0:3], v[184:187], v[136:139], v[0:3]
    v_mfma_f32_16x16x32_bf16 v[4:7], v[188:191], v[136:139], v[4:7]
    v_mfma_f32_16x16x32_bf16 v[8:11], v[192:195], v[136:139], v[8:11]
    v_mfma_f32_16x16x32_bf16 v[12:15], v[196:199], v[136:139], v[12:15]
    v_mfma_f32_16x16x32_bf16 v[16:19], v[200:203], v[136:139], v[16:19]
    s_waitcnt vmcnt(6)
    v_mfma_f32_16x16x32_bf16 v[20:23], v[184:187], v[140:143], v[20:23]
    v_mfma_f32_16x16x32_bf16 v[24:27], v[188:191], v[140:143], v[24:27]
    v_mfma_f32_16x16x32_bf16 v[28:31], v[192:195], v[140:143], v[28:31]
    v_mfma_f32_16x16x32_bf16 v[32:35], v[196:199], v[140:143], v[32:35]
    v_mfma_f32_16x16x32_bf16 v[36:39], v[200:203], v[140:143], v[36:39]
    s_waitcnt vmcnt(5)
    v_mfma_f32_16x16x32_bf16 v[40:43], v[184:187], v[144:147], v[40:43]
    v_mfma_f32_16x16x32_bf16 v[44:47], v[188:191], v[144:147], v[44:47]
    v_mfma_f32_16x16x32_bf16 v[48:51], v[192:195], v[144:147], v[48:51]
    v_mfma_f32_16x16x32_bf16 v[52:55], v[196:199], v[144:147], v[52:55]
    v_mfma_f32_16x16x32_bf16 v[56:59], v[200:203], v[144:147], v[56:59]
    s_waitcnt vmcnt(4)
    v_mfma_f32_16x16x32_bf16 v[60:63], v[184:187], v[148:151], v[60:63]
    v_mfma_f32_16x16x32_bf16 v[64:67], v[188:191], v[148:151], v[64:67]
    v_mfma_f32_16x16x32_bf16 v[68:71], v[192:195], v[148:151], v[68:71]
    v_mfma_f32_16x16x32_bf16 v[72:75], v[196:199], v[148:151], v[72:75]
    v_mfma_f32_16x16x32_bf16 v[76:79], v[200:203], v[148:151], v[76:79]
    s_add_u32 s68, s93, 7
    s_lshl_b32 s68, s68, 10
    s_add_u32 s68, s68, s76
    buffer_load_dwordx4 v[168:171], v244, s[36:39], s68 offen sc1
    buffer_load_dwordx4 v[172:175], v245, s[36:39], s68 offen sc1
    buffer_load_dwordx4 v[176:179], v246, s[36:39], s68 offen sc1
    buffer_load_dwordx4 v[180:183], v247, s[36:39], s68 offen sc1
    s_add_u32 s68, s93, 8
    s_lshl_b32 s68, s68, 10
    s_add_u32 s68, s68, s76
    buffer_load_dwordx4 v[80:83], v244, s[36:39], s68 offen sc1
    buffer_load_dwordx4 v[84:87], v245, s[36:39], s68 offen sc1
    buffer_load_dwordx4 v[88:91], v246, s[36:39], s68 offen sc1
    buffer_load_dwordx4 v[92:95], v247, s[36:39], s68 offen sc1
    s_cmp_lt_u32 s40, 2
    s_cbranch_scc0 SK_49
    s_mov_b32 s68, s50
    s_lshl_b32 s68, s68, 10
    s_add_u32 s68, s68, s76
    buffer_load_dwordx4 v[136:139], v244, s[36:39], s68 offen sc1
SK_49:
    s_cmp_lt_u32 s40, 2
    s_cbranch_scc0 SK_50
    buffer_load_dwordx4 v[140:143], v245, s[36:39], s68 offen sc1
SK_50:
    s_cmp_lt_u32 s40, 2
    s_cbranch_scc0 SK_51
    buffer_load_dwordx4 v[144:147], v246, s[36:39], s68 offen sc1
SK_51:
    s_cmp_lt_u32 s40, 2
    s_cbranch_scc0 SK_52
    buffer_load_dwordx4 v[148:151], v247, s[36:39], s68 offen sc1
SK_52:
    s_cmp_lt_u32 s40, 2
    s_cbranch_scc0 SK_53
    s_mov_b32 s88, s50
    s_add_u32 s88, s88, s94
    s_mul_i32 s88, s88, 5120
    s_add_u32 s89, s88, 4096
    buffer_load_dwordx4 v[116:119], v254, s[52:55], s88 offen offset:0 sc1
SK_53:
    s_cmp_lt_u32 s40, 2
    s_cbranch_scc0 SK_54
    buffer_load_dwordx4 v[120:123], v254, s[52:55], s88 offen offset:1024 sc1
SK_54:
    s_cmp_lt_u32 s40, 2
    s_cbranch_scc0 SK_55
    buffer_load_dwordx4 v[124:127], v254, s[52:55], s88 offen offset:2048 sc1
SK_55:
    s_cmp_lt_u32 s40, 2
    s_cbranch_scc0 SK_56
    buffer_load_dwordx4 v[128:131], v254, s[52:55], s88 offen offset:3072 sc1
SK_56:
    s_cmp_lt_u32 s40, 2
    s_cbranch_scc0 SK_57
    buffer_load_dwordx4 v[132:135], v254, s[52:55], s89 offen sc1
SK_57:
    s_barrier
    s_waitcnt vmcnt(11) lgkmcnt(0)
    v_mfma_f32_16x16x32_bf16 v[0:3], v[204:207], v[152:155], v[0:3]
    v_mfma_f32_16x16x32_bf16 v[4:7], v[208:211], v[152:155], v[4:7]
    v_mfma_f32_16x16x32_bf16 v[8:11], v[212:215], v[152:155], v[8:11]
    v_mfma_f32_16x16x32_bf16 v[12:15], v[216:219], v[152:155], v[12:15]
    v_mfma_f32_16x16x32_bf16 v[16:19], v[220:223], v[152:155], v[16:19]
    s_waitcnt vmcnt(10)
    v_mfma_f32_16x16x32_bf16 v[20:23], v[204:207], v[156:159], v[20:23]
    v_mfma_f32_16x16x32_bf16 v[24:27], v[208:211], v[156:159], v[24:27]
    v_mfma_f32_16x16x32_bf16 v[28:31], v[212:215], v[156:159], v[28:31]
    v_mfma_f32_16x16x32_bf16 v[32:35], v[216:219], v[156:159], v[32:35]
    v_mfma_f32_16x16x32_bf16 v[36:39], v[220:223], v[156:159], v[36:39]
    s_waitcnt vmcnt(9)
    v_mfma_f32_16x16x32_bf16 v[40:43], v[204:207], v[160:163], v[40:43]
    v_mfma_f32_16x16x32_bf16 v[44:47], v[208:211], v[160:163], v[44:47]
    v_mfma_f32_16x16x32_bf16 v[48:51], v[212:215], v[160:163], v[48:51]
    v_mfma_f32_16x16x32_bf16 v[52:55], v[216:219], v[160:163], v[52:55]
    v_mfma_f32_16x16x32_bf16 v[56:59], v[220:223], v[160:163], v[56:59]
    s_waitcnt vmcnt(8)
    v_mfma_f32_16x16x32_bf16 v[60:63], v[204:207], v[164:167], v[60:63]
    v_mfma_f32_16x16x32_bf16 v[64:67], v[208:211], v[164:167], v[64:67]
    v_mfma_f32_16x16x32_bf16 v[68:71], v[212:215], v[164:167], v[68:71]
    v_mfma_f32_16x16x32_bf16 v[72:75], v[216:219], v[164:167], v[72:75]
    v_mfma_f32_16x16x32_bf16 v[76:79], v[220:223], v[164:167], v[76:79]
    s_waitcnt vmcnt(7) lgkmcnt(0)
    v_mfma_f32_16x16x32_bf16 v[0:3], v[224:227], v[168:171], v[0:3]
    v_mfma_f32_16x16x32_bf16 v[4:7], v[228:231], v[168:171], v[4:7]
    v_mfma_f32_16x16x32_bf16 v[8:11], v[232:235], v[168:171], v[8:11]
    v_mfma_f32_16x16x32_bf16 v[12:15], v[236:239], v[168:171], v[12:15]
    v_mfma_f32_16x16x32_bf16 v[16:19], v[240:243], v[168:171], v[16:19]
    s_waitcnt vmcnt(6)
    v_mfma_f32_16x16x32_bf16 v[20:23], v[224:227], v[172:175], v[20:23]
    v_mfma_f32_16x16x32_bf16 v[24:27], v[228:231], v[172:175], v[24:27]
    v_mfma_f32_16x16x32_bf16 v[28:31], v[232:235], v[172:175], v[28:31]
    v_mfma_f32_16x16x32_bf16 v[32:35], v[236:239], v[172:175], v[32:35]
    v_mfma_f32_16x16x32_bf16 v[36:39], v[240:243], v[172:175], v[36:39]
    s_waitcnt vmcnt(5)
    v_mfma_f32_16x16x32_bf16 v[40:43], v[224:227], v[176:179], v[40:43]
    v_mfma_f32_16x16x32_bf16 v[44:47], v[228:231], v[176:179], v[44:47]
    v_mfma_f32_16x16x32_bf16 v[48:51], v[232:235], v[176:179], v[48:51]
    v_mfma_f32_16x16x32_bf16 v[52:55], v[236:239], v[176:179], v[52:55]
    v_mfma_f32_16x16x32_bf16 v[56:59], v[240:243], v[176:179], v[56:59]
    s_waitcnt vmcnt(4)
    v_mfma_f32_16x16x32_bf16 v[60:63], v[224:227], v[180:183], v[60:63]
    v_mfma_f32_16x16x32_bf16 v[64:67], v[228:231], v[180:183], v[64:67]
    v_mfma_f32_16x16x32_bf16 v[68:71], v[232:235], v[180:183], v[68:71]
    v_mfma_f32_16x16x32_bf16 v[72:75], v[236:239], v[180:183], v[72:75]
    v_mfma_f32_16x16x32_bf16 v[76:79], v[240:243], v[180:183], v[76:79]
    s_waitcnt vmcnt(3) lgkmcnt(0)
    v_mfma_f32_16x16x32_bf16 v[0:3], v[96:99], v[80:83], v[0:3]
    v_mfma_f32_16x16x32_bf16 v[4:7], v[100:103], v[80:83], v[4:7]
    v_mfma_f32_16x16x32_bf16 v[8:11], v[104:107], v[80:83], v[8:11]
    v_mfma_f32_16x16x32_bf16 v[12:15], v[108:111], v[80:83], v[12:15]
    v_mfma_f32_16x16x32_bf16 v[16:19], v[112:115], v[80:83], v[16:19]
    s_waitcnt vmcnt(2)
    v_mfma_f32_16x16x32_bf16 v[20:23], v[96:99], v[84:87], v[20:23]
    v_mfma_f32_16x16x32_bf16 v[24:27], v[100:103], v[84:87], v[24:27]
    v_mfma_f32_16x16x32_bf16 v[28:31], v[104:107], v[84:87], v[28:31]
    v_mfma_f32_16x16x32_bf16 v[32:35], v[108:111], v[84:87], v[32:35]
    v_mfma_f32_16x16x32_bf16 v[36:39], v[112:115], v[84:87], v[36:39]
    s_waitcnt vmcnt(1)
    v_mfma_f32_16x16x32_bf16 v[40:43], v[96:99], v[88:91], v[40:43]
    v_mfma_f32_16x16x32_bf16 v[44:47], v[100:103], v[88:91], v[44:47]
    v_mfma_f32_16x16x32_bf16 v[48:51], v[104:107], v[88:91], v[48:51]
    v_mfma_f32_16x16x32_bf16 v[52:55], v[108:111], v[88:91], v[52:55]
    v_mfma_f32_16x16x32_bf16 v[56:59], v[112:115], v[88:91], v[56:59]
    s_waitcnt vmcnt(0)
    v_mfma_f32_16x16x32_bf16 v[60:63], v[96:99], v[92:95], v[60:63]
    v_mfma_f32_16x16x32_bf16 v[64:67], v[100:103], v[92:95], v[64:67]
    v_mfma_f32_16x16x32_bf16 v[68:71], v[104:107], v[92:95], v[68:71]
    v_mfma_f32_16x16x32_bf16 v[72:75], v[108:111], v[92:95], v[72:75]
    v_mfma_f32_16x16x32_bf16 v[76:79], v[112:115], v[92:95], v[76:79]
    s_cmp_ge_u32 s40, 2
    s_cbranch_scc1 P2_SK9
    s_waitcnt vmcnt(0)
    v_mfma_f32_16x16x32_bf16 v[0:3], v[116:119], v[136:139], v[0:3]
    v_mfma_f32_16x16x32_bf16 v[4:7], v[120:123], v[136:139], v[4:7]
    v_mfma_f32_16x16x32_bf16 v[8:11], v[124:127], v[136:139], v[8:11]
    v_mfma_f32_16x16x32_bf16 v[12:15], v[128:131], v[136:139], v[12:15]
    v_mfma_f32_16x16x32_bf16 v[16:19], v[132:135], v[136:139], v[16:19]
    s_waitcnt vmcnt(0)
    v_mfma_f32_16x16x32_bf16 v[20:23], v[116:119], v[140:143], v[20:23]
    v_mfma_f32_16x16x32_bf16 v[24:27], v[120:123], v[140:143], v[24:27]
    v_mfma_f32_16x16x32_bf16 v[28:31], v[124:127], v[140:143], v[28:31]
    v_mfma_f32_16x16x32_bf16 v[32:35], v[128:131], v[140:143], v[32:35]
    v_mfma_f32_16x16x32_bf16 v[36:39], v[132:135], v[140:143], v[36:39]
    s_waitcnt vmcnt(0)
    v_mfma_f32_16x16x32_bf16 v[40:43], v[116:119], v[144:147], v[40:43]
    v_mfma_f32_16x16x32_bf16 v[44:47], v[120:123], v[144:147], v[44:47]
    v_mfma_f32_16x16x32_bf16 v[48:51], v[124:127], v[144:147], v[48:51]
    v_mfma_f32_16x16x32_bf16 v[52:55], v[128:131], v[144:147], v[52:55]
    v_mfma_f32_16x16x32_bf16 v[56:59], v[132:135], v[144:147], v[56:59]
    s_waitcnt vmcnt(0)
    v_mfma_f32_16x16x32_bf16 v[60:63], v[116:119], v[148:151], v[60:63]
    v_mfma_f32_16x16x32_bf16 v[64:67], v[120:123], v[148:151], v[64:67]
    v_mfma_f32_16x16x32_bf16 v[68:71], v[124:127], v[148:151], v[68:71]
    v_mfma_f32_16x16x32_bf16 v[72:75], v[128:131], v[148:151], v[72:75]
    v_mfma_f32_16x16x32_bf16 v[76:79], v[132:135], v[148:151], v[76:79]
P2_SK9:
    ds_write_b128 v248, v[0:3] offset:0
    ds_write_b128 v248, v[4:7] offset:8192
    ds_write_b128 v248, v[8:11] offset:16384
    ds_write_b128 v248, v[12:15] offset:24576
    ds_write_b128 v248, v[16:19] offset:32768
    ds_write_b128 v248, v[20:23] offset:40960
    ds_write_b128 v248, v[24:27] offset:49152
    ds_write_b128 v248, v[28:31] offset:57344
    ds_write_b128 v249, v[32:35] offset:0
    ds_write_b128 v249, v[36:39] offset:8192
    ds_write_b128 v249, v[40:43] offset:16384
    ds_write_b128 v249, v[44:47] offset:24576
    ds_write_b128 v249, v[48:51] offset:32768
    ds_write_b128 v249, v[52:55] offset:40960
    ds_write_b128 v249, v[56:59] offset:49152
    ds_write_b128 v249, v[60:63] offset:57344
    ds_write_b128 v253, v[64:67] offset:0
    ds_write_b128 v253, v[68:71] offset:8192
    ds_write_b128 v253, v[72:75] offset:16384
    ds_write_b128 v253, v[76:79] offset:24576
    s_waitcnt lgkmcnt(0)
    s_barrier
    s_endpgm
P2_YOUNG:
    s_barrier
    s_add_u32 s68, s92, 0
    s_lshl_b32 s68, s68, 10
    s_add_u32 s68, s68, s76
    buffer_load_dwordx4 v[80:83], v244, s[36:39], s68 offen sc1
    buffer_load_dwordx4 v[84:87], v245, s[36:39], s68 offen sc1
    buffer_load_dwordx4 v[88:91], v246, s[36:39], s68 offen sc1
    buffer_load_dwordx4 v[92:95], v247, s[36:39], s68 offen sc1
    s_waitcnt vmcnt(8)
    s_barrier
    s_xor_b32 s68, s40, 4
    s_lshl_b32 s68, s68, 8
    s_or_b32 s68, s68, s2
    s_cmp_lt_u32 s68, 96
    s_cbranch_scc0 SK_58
    v_mov_b32 v252, 1
    s_mov_b64 exec, 1
    buffer_atomic_add v252, off, s[60:63], s96 sc1
    s_mov_b64 exec, -1
SK_58:
    s_add_u32 s68, s92, 1
    s_lshl_b32 s68, s68, 10
    s_add_u32 s68, s68, s76
    buffer_load_dwordx4 v[136:139], v244, s[36:39], s68 offen sc1
    buffer_load_dwordx4 v[140:143], v245, s[36:39], s68 offen sc1
    buffer_load_dwordx4 v[144:147], v246, s[36:39], s68 offen sc1
    buffer_load_dwordx4 v[148:151], v247, s[36:39], s68 offen sc1
    s_add_u32 s68, s92, 2
    s_lshl_b32 s68, s68, 10
    s_add_u32 s68, s68, s76
    buffer_load_dwordx4 v[152:155], v244, s[36:39], s68 offen sc1
    buffer_load_dwordx4 v[156:159], v245, s[36:39], s68 offen sc1
    buffer_load_dwordx4 v[160:163], v246, s[36:39], s68 offen sc1
    buffer_load_dwordx4 v[164:167], v247, s[36:39], s68 offen sc1
    s_barrier
    s_waitcnt vmcnt(11)
    v_mfma_f32_16x16x32_bf16 v[0:3], v[184:187], v[80:83], 0
    v_mfma_f32_16x16x32_bf16 v[4:7], v[188:191], v[80:83], 0
    v_mfma_f32_16x16x32_bf16 v[8:11], v[192:195], v[80:83], 0
    v_mfma_f32_16x16x32_bf16 v[12:15], v[196:199], v[80:83], 0
    v_mfma_f32_16x16x32_bf16 v[16:19], v[200:203], v[80:83], 0
    s_waitcnt vmcnt(10)
    v_mfma_f32_16x16x32_bf16 v[20:23], v[184:187], v[84:87], 0
    v_mfma_f32_16x16x32_bf16 v[24:27], v[188:191], v[84:87], 0
    v_mfma_f32_16x16x32_bf16 v[28:31], v[192:195], v[84:87], 0
    v_mfma_f32_16x16x32_bf16 v[32:35], v[196:199], v[84:87], 0
    v_mfma_f32_16x16x32_bf16 v[36:39], v[200:203], v[84:87], 0
    s_waitcnt vmcnt(9)
    v_mfma_f32_16x16x32_bf16 v[40:43], v[184:187], v[88:91], 0
    v_mfma_f32_16x16x32_bf16 v[44:47], v[188:191], v[88:91], 0
    v_mfma_f32_16x16x32_bf16 v[48:51], v[192:195], v[88:91], 0
    v_mfma_f32_16x16x32_bf16 v[52:55], v[196:199], v[88:91], 0
    v_mfma_f32_16x16x32_bf16 v[56:59], v[200:203], v[88:91], 0
    s_waitcnt vmcnt(8)
    v_mfma_f32_16x16x32_bf16 v[60:63], v[184:187], v[92:95], 0
    v_mfma_f32_16x16x32_bf16 v[64:67], v[188:191], v[92:95], 0
    v_mfma_f32_16x16x32_bf16 v[68:71], v[192:195], v[92:95], 0
    v_mfma_f32_16x16x32_bf16 v[72:75], v[196:199], v[92:95], 0
    v_mfma_f32_16x16x32_bf16 v[76:79], v[200:203], v[92:95], 0
    s_waitcnt vmcnt(7)
    v_mfma_f32_16x16x32_bf16 v[0:3], v[204:207], v[136:139], v[0:3]
    v_mfma_f32_16x16x32_bf16 v[4:7], v[208:211], v[136:139], v[4:7]
    v_mfma_f32_16x16x32_bf16 v[8:11], v[212:215], v[136:139], v[8:11]
    v_mfma_f32_16x16x32_bf16 v[12:15], v[216:219], v[136:139], v[12:15]
    v_mfma_f32_16x16x32_bf16 v[16:19], v[220:223], v[136:139], v[16:19]
    s_waitcnt vmcnt(6)
    v_mfma_f32_16x16x32_bf16 v[20:23], v[204:207], v[140:143], v[20:23]
    v_mfma_f32_16x16x32_bf16 v[24:27], v[208:211], v[140:143], v[24:27]
    v_mfma_f32_16x16x32_bf16 v[28:31], v[212:215], v[140:143], v[28:31]
    v_mfma_f32_16x16x32_bf16 v[32:35], v[216:219], v[140:143], v[32:35]
    v_mfma_f32_16x16x32_bf16 v[36:39], v[220:223], v[140:143], v[36:39]
    s_waitcnt vmcnt(5)
    v_mfma_f32_16x16x32_bf16 v[40:43], v[204:207], v[144:147], v[40:43]
    v_mfma_f32_16x16x32_bf16 v[44:47], v[208:211], v[144:147], v[44:47]
    v_mfma_f32_16x16x32_bf16 v[48:51], v[212:215], v[144:147], v[48:51]
    v_mfma_f32_16x16x32_bf16 v[52:55], v[216:219], v[144:147], v[52:55]
    v_mfma_f32_16x16x32_bf16 v[56:59], v[220:223], v[144:147], v[56:59]
    s_waitcnt vmcnt(4)
    v_mfma_f32_16x16x32_bf16 v[60:63], v[204:207], v[148:151], v[60:63]
    v_mfma_f32_16x16x32_bf16 v[64:67], v[208:211], v[148:151], v[64:67]
    v_mfma_f32_16x16x32_bf16 v[68:71], v[212:215], v[148:151], v[68:71]
    v_mfma_f32_16x16x32_bf16 v[72:75], v[216:219], v[148:151], v[72:75]
    v_mfma_f32_16x16x32_bf16 v[76:79], v[220:223], v[148:151], v[76:79]
    s_barrier
    s_add_u32 s68, s92, 3
    s_lshl_b32 s68, s68, 10
    s_add_u32 s68, s68, s76
    buffer_load_dwordx4 v[168:171], v244, s[36:39], s68 offen sc1
    buffer_load_dwordx4 v[172:175], v245, s[36:39], s68 offen sc1
    buffer_load_dwordx4 v[176:179], v246, s[36:39], s68 offen sc1
    buffer_load_dwordx4 v[180:183], v247, s[36:39], s68 offen sc1
    s_add_u32 s68, s92, 4
    s_lshl_b32 s68, s68, 10
    s_add_u32 s68, s68, s76
    buffer_load_dwordx4 v[80:83], v244, s[36:39], s68 offen sc1
    buffer_load_dwordx4 v[84:87], v245, s[36:39], s68 offen sc1
    buffer_load_dwordx4 v[88:91], v246, s[36:39], s68 offen sc1
    buffer_load_dwordx4 v[92:95], v247, s[36:39], s68 offen sc1
    ds_read_b128 v[184:187], v248 offset:24576
    ds_read_b128 v[188:191], v248 offset:32768
    ds_read_b128 v[192:195], v248 offset:40960
    ds_read_b128 v[196:199], v248 offset:49152
    ds_read_b128 v[200:203], v248 offset:57344
    ds_read_b128 v[204:207], v249 offset:0
    ds_read_b128 v[208:211], v248 offset:0
    ds_read_b128 v[212:215], v248 offset:8192
    ds_read_b128 v[216:219], v248 offset:16384
    ds_read_b128 v[220:223], v253 offset:24576
    s_waitcnt vmcnt(11)
    v_mfma_f32_16x16x32_bf16 v[0:3], v[224:227], v[152:155], v[0:3]
    v_mfma_f32_16x16x32_bf16 v[4:7], v[228:231], v[152:155], v[4:7]
    v_mfma_f32_16x16x32_bf16 v[8:11], v[232:235], v[152:155], v[8:11]
    v_mfma_f32_16x16x32_bf16 v[12:15], v[236:239], v[152:155], v[12:15]
    v_mfma_f32_16x16x32_bf16 v[16:19], v[240:243], v[152:155], v[16:19]
    s_waitcnt vmcnt(10)
    v_mfma_f32_16x16x32_bf16 v[20:23], v[224:227], v[156:159], v[20:23]
    v_mfma_f32_16x16x32_bf16 v[24:27], v[228:231], v[156:159], v[24:27]
    v_mfma_f32_16x16x32_bf16 v[28:31], v[232:235], v[156:159], v[28:31]
    v_mfma_f32_16x16x32_bf16 v[32:35], v[236:239], v[156:159], v[32:35]
    v_mfma_f32_16x16x32_bf16 v[36:39], v[240:243], v[156:159], v[36:39]
    s_waitcnt vmcnt(9)
    v_mfma_f32_16x16x32_bf16 v[40:43], v[224:227], v[160:163], v[40:43]
    v_mfma_f32_16x16x32_bf16 v[44:47], v[228:231], v[160:163], v[44:47]
    v_mfma_f32_16x16x32_bf16 v[48:51], v[232:235], v[160:163], v[48:51]
    v_mfma_f32_16x16x32_bf16 v[52:55], v[236:239], v[160:163], v[52:55]
    v_mfma_f32_16x16x32_bf16 v[56:59], v[240:243], v[160:163], v[56:59]
    s_waitcnt vmcnt(8)
    v_mfma_f32_16x16x32_bf16 v[60:63], v[224:227], v[164:167], v[60:63]
    v_mfma_f32_16x16x32_bf16 v[64:67], v[228:231], v[164:167], v[64:67]
    v_mfma_f32_16x16x32_bf16 v[68:71], v[232:235], v[164:167], v[68:71]
    v_mfma_f32_16x16x32_bf16 v[72:75], v[236:239], v[164:167], v[72:75]
    v_mfma_f32_16x16x32_bf16 v[76:79], v[240:243], v[164:167], v[76:79]
    s_waitcnt vmcnt(7)
    v_mfma_f32_16x16x32_bf16 v[0:3], v[96:99], v[168:171], v[0:3]
    v_mfma_f32_16x16x32_bf16 v[4:7], v[100:103], v[168:171], v[4:7]
    v_mfma_f32_16x16x32_bf16 v[8:11], v[104:107], v[168:171], v[8:11]
    v_mfma_f32_16x16x32_bf16 v[12:15], v[108:111], v[168:171], v[12:15]
    v_mfma_f32_16x16x32_bf16 v[16:19], v[112:115], v[168:171], v[16:19]
    s_waitcnt vmcnt(6)
    v_mfma_f32_16x16x32_bf16 v[20:23], v[96:99], v[172:175], v[20:23]
    v_mfma_f32_16x16x32_bf16 v[24:27], v[100:103], v[172:175], v[24:27]
    v_mfma_f32_16x16x32_bf16 v[28:31], v[104:107], v[172:175], v[28:31]
    v_mfma_f32_16x16x32_bf16 v[32:35], v[108:111], v[172:175], v[32:35]
    v_mfma_f32_16x16x32_bf16 v[36:39], v[112:115], v[172:175], v[36:39]
    s_waitcnt vmcnt(5)
    v_mfma_f32_16x16x32_bf16 v[40:43], v[96:99], v[176:179], v[40:43]
    v_mfma_f32_16x16x32_bf16 v[44:47], v[100:103], v[176:179], v[44:47]
    v_mfma_f32_16x16x32_bf16 v[48:51], v[104:107], v[176:179], v[48:51]
    v_mfma_f32_16x16x32_bf16 v[52:55], v[108:111], v[176:179], v[52:55]
    v_mfma_f32_16x16x32_bf16 v[56:59], v[112:115], v[176:179], v[56:59]
    s_waitcnt vmcnt(4)
    v_mfma_f32_16x16x32_bf16 v[60:63], v[96:99], v[180:183], v[60:63]
    v_mfma_f32_16x16x32_bf16 v[64:67], v[100:103], v[180:183], v[64:67]
    v_mfma_f32_16x16x32_bf16 v[68:71], v[104:107], v[180:183], v[68:71]
    v_mfma_f32_16x16x32_bf16 v[72:75], v[108:111], v[180:183], v[72:75]
    v_mfma_f32_16x16x32_bf16 v[76:79], v[112:115], v[180:183], v[76:79]
    s_barrier
    s_add_u32 s68, s92, 5
    s_lshl_b32 s68, s68, 10
    s_add_u32 s68, s68, s76
    buffer_load_dwordx4 v[136:139], v244, s[36:39], s68 offen sc1
    buffer_load_dwordx4 v[140:143], v245, s[36:39], s68 offen sc1
    buffer_load_dwordx4 v[144:147], v246, s[36:39], s68 offen sc1
    buffer_load_dwordx4 v[148:151], v247, s[36:39], s68 offen sc1
    s_mov_b32 s68, s95
    s_lshl_b32 s68, s68, 10
    s_add_u32 s68, s68, s76
    buffer_load_dwordx4 v[152:155], v244, s[36:39], s68 offen sc1
    buffer_load_dwordx4 v[156:159], v245, s[36:39], s68 offen sc1
    buffer_load_dwordx4 v[160:163], v246, s[36:39], s68 offen sc1
    buffer_load_dwordx4 v[164:167], v247, s[36:39], s68 offen sc1
    ds_read_b128 v[224:227], v249 offset:8192
    ds_read_b128 v[228:231], v249 offset:16384
    ds_read_b128 v[232:235], v249 offset:24576
    ds_read_b128 v[236:239], v249 offset:32768
    ds_read_b128 v[240:243], v249 offset:40960
    ds_read_b128 v[96:99], v249 offset:49152
    ds_read_b128 v[100:103], v249 offset:57344
    ds_read_b128 v[104:107], v253 offset:0
    ds_read_b128 v[108:111], v253 offset:8192
    ds_read_b128 v[112:115], v253 offset:16384
    s_waitcnt vmcnt(11)
    v_mfma_f32_16x16x32_bf16 v[0:3], v[116:119], v[80:83], v[0:3]
    v_mfma_f32_16x16x32_bf16 v[4:7], v[120:123], v[80:83], v[4:7]
    v_mfma_f32_16x16x32_bf16 v[8:11], v[124:127], v[80:83], v[8:11]
    v_mfma_f32_16x16x32_bf16 v[12:15], v[128:131], v[80:83], v[12:15]
    v_mfma_f32_16x16x32_bf16 v[16:19], v[132:135], v[80:83], v[16:19]
    s_waitcnt vmcnt(10)
    v_mfma_f32_16x16x32_bf16 v[20:23], v[116:119], v[84:87], v[20:23]
    v_mfma_f32_16x16x32_bf16 v[24:27], v[120:123], v[84:87], v[24:27]
    v_mfma_f32_16x16x32_bf16 v[28:31], v[124:127], v[84:87], v[28:31]
    v_mfma_f32_16x16x32_bf16 v[32:35], v[128:131], v[84:87], v[32:35]
    v_mfma_f32_16x16x32_bf16 v[36:39], v[132:135], v[84:87], v[36:39]
    s_waitcnt vmcnt(9)
    v_mfma_f32_16x16x32_bf16 v[40:43], v[116:119], v[88:91], v[40:43]
    v_mfma_f32_16x16x32_bf16 v[44:47], v[120:123], v[88:91], v[44:47]
    v_mfma_f32_16x16x32_bf16 v[48:51], v[124:127], v[88:91], v[48:51]
    v_mfma_f32_16x16x32_bf16 v[52:55], v[128:131], v[88:91], v[52:55]
    v_mfma_f32_16x16x32_bf16 v[56:59], v[132:135], v[88:91], v[56:59]
    s_waitcnt vmcnt(8)
    v_mfma_f32_16x16x32_bf16 v[60:63], v[116:119], v[92:95], v[60:63]
    v_mfma_f32_16x16x32_bf16 v[64:67], v[120:123], v[92:95], v[64:67]
    v_mfma_f32_16x16x32_bf16 v[68:71], v[124:127], v[92:95], v[68:71]
    v_mfma_f32_16x16x32_bf16 v[72:75], v[128:131], v[92:95], v[72:75]
    v_mfma_f32_16x16x32_bf16 v[76:79], v[132:135], v[92:95], v[76:79]
    s_waitcnt vmcnt(7) lgkmcnt(0)
    v_mfma_f32_16x16x32_bf16 v[0:3], v[184:187], v[136:139], v[0:3]
    v_mfma_f32_16x16x32_bf16 v[4:7], v[188:191], v[136:139], v[4:7]
    v_mfma_f32_16x16x32_bf16 v[8:11], v[192:195], v[136:139], v[8:11]
    v_mfma_f32_16x16x32_bf16 v[12:15], v[196:199], v[136:139], v[12:15]
    v_mfma_f32_16x16x32_bf16 v[16:19], v[200:203], v[136:139], v[16:19]
    s_waitcnt vmcnt(6)
    v_mfma_f32_16x16x32_bf16 v[20:23], v[184:187], v[140:143], v[20:23]
    v_mfma_f32_16x16x32_bf16 v[24:27], v[188:191], v[140:143], v[24:27]
    v_mfma_f32_16x16x32_bf16 v[28:31], v[192:195], v[140:143], v[28:31]
    v_mfma_f32_16x16x32_bf16 v[32:35], v[196:199], v[140:143], v[32:35]
    v_mfma_f32_16x16x32_bf16 v[36:39], v[200:203], v[140:143], v[36:39]
    s_waitcnt vmcnt(5)
    v_mfma_f32_16x16x32_bf16 v[40:43], v[184:187], v[144:147], v[40:43]
    v_mfma_f32_16x16x32_bf16 v[44:47], v[188:191], v[144:147], v[44:47]
    v_mfma_f32_16x16x32_bf16 v[48:51], v[192:195], v[144:147], v[48:51]
    v_mfma_f32_16x16x32_bf16 v[52:55], v[196:199], v[144:147], v[52:55]
    v_mfma_f32_16x16x32_bf16 v[56:59], v[200:203], v[144:147], v[56:59]
    s_waitcnt vmcnt(4)
    v_mfma_f32_16x16x32_bf16 v[60:63], v[184:187], v[148:151], v[60:63]
    v_mfma_f32_16x16x32_bf16 v[64:67], v[188:191], v[148:151], v[64:67]
    v_mfma_f32_16x16x32_bf16 v[68:71], v[192:195], v[148:151], v[68:71]
    v_mfma_f32_16x16x32_bf16 v[72:75], v[196:199], v[148:151], v[72:75]
    v_mfma_f32_16x16x32_bf16 v[76:79], v[200:203], v[148:151], v[76:79]
    s_barrier
    s_add_u32 s68, s93, 7
    s_lshl_b32 s68, s68, 10
    s_add_u32 s68, s68, s76
    buffer_load_dwordx4 v[168:171], v244, s[36:39], s68 offen sc1
    buffer_load_dwordx4 v[172:175], v245, s[36:39], s68 offen sc1
    buffer_load_dwordx4 v[176:179], v246, s[36:39], s68 offen sc1
    buffer_load_dwordx4 v[180:183], v247, s[36:39], s68 offen sc1
    s_add_u32 s68, s93, 8
    s_lshl_b32 s68, s68, 10
    s_add_u32 s68, s68, s76
    buffer_load_dwordx4 v[80:83], v244, s[36:39], s68 offen sc1
    buffer_load_dwordx4 v[84:87], v245, s[36:39], s68 offen sc1
    buffer_load_dwordx4 v[88:91], v246, s[36:39], s68 offen sc1
    buffer_load_dwordx4 v[92:95], v247, s[36:39], s68 offen sc1
    s_and_b32 s80, s40, 3
    s_lshl_b32 s81, s90, 2
    s_add_u32 s81, s81, s80
    s_mul_i32 s81, s81, 20480
    s_mul_i32 s82, s91, 160
    s_add_u32 s81, s81, s82
    v_and_b32 v244, 15, v255
    v_mul_u32_u24 v244, 1280, v244
    v_lshrrev_b32 v245, 4, v255
    v_lshl_add_u32 v246, v245, 3, v244
    s_mov_b32 s72, s4
    s_mov_b32 s73, s5
    s_mov_b32 s74, 2621440
    s_mov_b32 s75, 0x20000
    buffer_load_dwordx2 v[188:189], v246, s[72:75], s81 offen offset:0
    buffer_load_dwordx2 v[190:191], v246, s[72:75], s81 offen offset:32
    buffer_load_dwordx2 v[192:193], v246, s[72:75], s81 offen offset:64
    buffer_load_dwordx2 v[194:195], v246, s[72:75], s81 offen offset:96
    buffer_load_dwordx2 v[196:197], v246, s[72:75], s81 offen offset:128
    s_mov_b32 s84, s18
    s_mov_b32 s85, s19
    s_mov_b32 s86, 2621440
    s_mov_b32 s87, 0x20000
    s_sub_u32 s68, s40, 0
    s_and_b32 s68, s68, 3
    s_lshl_b32 s68, s68, 10
    s_add_u32 s68, s68, 0
    v_add_u32 v184, s68, v254
    s_sub_u32 s68, s40, 1
    s_and_b32 s68, s68, 3
    s_lshl_b32 s68, s68, 10
    s_add_u32 s68, s68, 40960
    v_add_u32 v199, s68, v254
    s_sub_u32 s68, s40, 2
    s_and_b32 s68, s68, 3
    s_lshl_b32 s68, s68, 10
    s_add_u32 s68, s68, 81920
    v_add_u32 v200, s68, v254
    s_sub_u32 s68, s40, 3
    s_and_b32 s68, s68, 3
    s_lshl_b32 s68, s68, 10
    s_add_u32 s68, s68, 122880
    v_add_u32 v201, s68, v254
    s_waitcnt vmcnt(16) lgkmcnt(0)
    v_mfma_f32_16x16x32_bf16 v[0:3], v[204:207], v[152:155], v[0:3]
    v_mfma_f32_16x16x32_bf16 v[4:7], v[208:211], v[152:155], v[4:7]
    v_mfma_f32_16x16x32_bf16 v[8:11], v[212:215], v[152:155], v[8:11]
    v_mfma_f32_16x16x32_bf16 v[12:15], v[216:219], v[152:155], v[12:15]
    v_mfma_f32_16x16x32_bf16 v[16:19], v[220:223], v[152:155], v[16:19]
    s_waitcnt vmcnt(15)
    v_mfma_f32_16x16x32_bf16 v[20:23], v[204:207], v[156:159], v[20:23]
    v_mfma_f32_16x16x32_bf16 v[24:27], v[208:211], v[156:159], v[24:27]
    v_mfma_f32_16x16x32_bf16 v[28:31], v[212:215], v[156:159], v[28:31]
    v_mfma_f32_16x16x32_bf16 v[32:35], v[216:219], v[156:159], v[32:35]
    v_mfma_f32_16x16x32_bf16 v[36:39], v[220:223], v[156:159], v[36:39]
    s_waitcnt vmcnt(14)
    v_mfma_f32_16x16x32_bf16 v[40:43], v[204:207], v[160:163], v[40:43]
    v_mfma_f32_16x16x32_bf16 v[44:47], v[208:211], v[160:163], v[44:47]
    v_mfma_f32_16x16x32_bf16 v[48:51], v[212:215], v[160:163], v[48:51]
    v_mfma_f32_16x16x32_bf16 v[52:55], v[216:219], v[160:163], v[52:55]
    v_mfma_f32_16x16x32_bf16 v[56:59], v[220:223], v[160:163], v[56:59]
    s_waitcnt vmcnt(13)
    v_mfma_f32_16x16x32_bf16 v[60:63], v[204:207], v[164:167], v[60:63]
    v_mfma_f32_16x16x32_bf16 v[64:67], v[208:211], v[164:167], v[64:67]
    v_mfma_f32_16x16x32_bf16 v[68:71], v[212:215], v[164:167], v[68:71]
    v_mfma_f32_16x16x32_bf16 v[72:75], v[216:219], v[164:167], v[72:75]
    v_mfma_f32_16x16x32_bf16 v[76:79], v[220:223], v[164:167], v[76:79]
    s_waitcnt vmcnt(12) lgkmcnt(0)
    v_mfma_f32_16x16x32_bf16 v[0:3], v[224:227], v[168:171], v[0:3]
    v_mfma_f32_16x16x32_bf16 v[4:7], v[228:231], v[168:171], v[4:7]
    v_mfma_f32_16x16x32_bf16 v[8:11], v[232:235], v[168:171], v[8:11]
    v_mfma_f32_16x16x32_bf16 v[12:15], v[236:239], v[168:171], v[12:15]
    v_mfma_f32_16x16x32_bf16 v[16:19], v[240:243], v[168:171], v[16:19]
    s_waitcnt vmcnt(11)
    v_mfma_f32_16x16x32_bf16 v[20:23], v[224:227], v[172:175], v[20:23]
    v_mfma_f32_16x16x32_bf16 v[24:27], v[228:231], v[172:175], v[24:27]
    v_mfma_f32_16x16x32_bf16 v[28:31], v[232:235], v[172:175], v[28:31]
    v_mfma_f32_16x16x32_bf16 v[32:35], v[236:239], v[172:175], v[32:35]
    v_mfma_f32_16x16x32_bf16 v[36:39], v[240:243], v[172:175], v[36:39]
    s_waitcnt vmcnt(10)
    v_mfma_f32_16x16x32_bf16 v[40:43], v[224:227], v[176:179], v[40:43]
    v_mfma_f32_16x16x32_bf16 v[44:47], v[228:231], v[176:179], v[44:47]
    v_mfma_f32_16x16x32_bf16 v[48:51], v[232:235], v[176:179], v[48:51]
    v_mfma_f32_16x16x32_bf16 v[52:55], v[236:239], v[176:179], v[52:55]
    v_mfma_f32_16x16x32_bf16 v[56:59], v[240:243], v[176:179], v[56:59]
    s_waitcnt vmcnt(9)
    v_mfma_f32_16x16x32_bf16 v[60:63], v[224:227], v[180:183], v[60:63]
    v_mfma_f32_16x16x32_bf16 v[64:67], v[228:231], v[180:183], v[64:67]
    v_mfma_f32_16x16x32_bf16 v[68:71], v[232:235], v[180:183], v[68:71]
    v_mfma_f32_16x16x32_bf16 v[72:75], v[236:239], v[180:183], v[72:75]
    v_mfma_f32_16x16x32_bf16 v[76:79], v[240:243], v[180:183], v[76:79]
    s_waitcnt vmcnt(0)
    v_lshlrev_b32 v116, 16, v188
    v_and_b32 v117, 0xffff0000, v188
    v_lshlrev_b32 v118, 16, v189
    v_and_b32 v119, 0xffff0000, v189
    v_lshlrev_b32 v120, 16, v190
    v_and_b32 v121, 0xffff0000, v190
    v_lshlrev_b32 v122, 16, v191
    v_and_b32 v123, 0xffff0000, v191
    v_lshlrev_b32 v124, 16, v192
    v_and_b32 v125, 0xffff0000, v192
    v_lshlrev_b32 v126, 16, v193
    v_and_b32 v127, 0xffff0000, v193
    v_lshlrev_b32 v128, 16, v194
    v_and_b32 v129, 0xffff0000, v194
    v_lshlrev_b32 v130, 16, v195
    v_and_b32 v131, 0xffff0000, v195
    v_lshlrev_b32 v132, 16, v196
    v_and_b32 v133, 0xffff0000, v196
    v_lshlrev_b32 v134, 16, v197
    v_and_b32 v135, 0xffff0000, v197
    v_pk_add_f32 v[0:1], v[0:1], v[116:117]
    v_pk_add_f32 v[2:3], v[2:3], v[118:119]
    v_pk_add_f32 v[4:5], v[4:5], v[120:121]
    v_pk_add_f32 v[6:7], v[6:7], v[122:123]
    v_pk_add_f32 v[8:9], v[8:9], v[124:125]
    v_pk_add_f32 v[10:11], v[10:11], v[126:127]
    v_pk_add_f32 v[12:13], v[12:13], v[128:129]
    v_pk_add_f32 v[14:15], v[14:15], v[130:131]
    v_pk_add_f32 v[16:17], v[16:17], v[132:133]
    v_pk_add_f32 v[18:19], v[18:19], v[134:135]
    s_waitcnt vmcnt(8) lgkmcnt(0)
    s_waitcnt vmcnt(5)
    s_waitcnt vmcnt(7)
    v_mfma_f32_16x16x32_bf16 v[20:23], v[96:99], v[84:87], v[20:23]
    v_mfma_f32_16x16x32_bf16 v[24:27], v[100:103], v[84:87], v[24:27]
    v_mfma_f32_16x16x32_bf16 v[28:31], v[104:107], v[84:87], v[28:31]
    v_mfma_f32_16x16x32_bf16 v[32:35], v[108:111], v[84:87], v[32:35]
    v_mfma_f32_16x16x32_bf16 v[36:39], v[112:115], v[84:87], v[36:39]
    s_waitcnt vmcnt(6)
    v_mfma_f32_16x16x32_bf16 v[40:43], v[96:99], v[88:91], v[40:43]
    s_nop 1
    ds_write_b128 v248, v[20:23] offset:40960
    v_mfma_f32_16x16x32_bf16 v[44:47], v[100:103], v[88:91], v[44:47]
    ds_write_b128 v248, v[24:27] offset:49152
    v_mfma_f32_16x16x32_bf16 v[48:51], v[104:107], v[88:91], v[48:51]
    ds_write_b128 v248, v[28:31] offset:57344
    v_mfma_f32_16x16x32_bf16 v[52:55], v[108:111], v[88:91], v[52:55]
    ds_write_b128 v249, v[32:35] offset:0
    v_mfma_f32_16x16x32_bf16 v[56:59], v[112:115], v[88:91], v[56:59]
    ds_write_b128 v249, v[36:39] offset:8192
    s_waitcnt vmcnt(5)
    v_mfma_f32_16x16x32_bf16 v[60:63], v[96:99], v[92:95], v[60:63]
    ds_write_b128 v249, v[40:43] offset:16384
    v_mfma_f32_16x16x32_bf16 v[64:67], v[100:103], v[92:95], v[64:67]
    ds_write_b128 v249, v[44:47] offset:24576
    v_mfma_f32_16x16x32_bf16 v[68:71], v[104:107], v[92:95], v[68:71]
    ds_write_b128 v249, v[48:51] offset:32768
    v_mfma_f32_16x16x32_bf16 v[72:75], v[108:111], v[92:95], v[72:75]
    ds_write_b128 v249, v[52:55] offset:40960
    v_mfma_f32_16x16x32_bf16 v[76:79], v[112:115], v[92:95], v[76:79]
    ds_write_b128 v249, v[56:59] offset:49152
    v_mfma_f32_16x16x32_bf16 v[0:3], v[96:99], v[80:83], v[0:3]
    ds_write_b128 v249, v[60:63] offset:57344
    v_mfma_f32_16x16x32_bf16 v[4:7], v[100:103], v[80:83], v[4:7]
    ds_write_b128 v253, v[64:67] offset:0
    v_mfma_f32_16x16x32_bf16 v[8:11], v[104:107], v[80:83], v[8:11]
    ds_write_b128 v253, v[68:71] offset:8192
    v_mfma_f32_16x16x32_bf16 v[12:15], v[108:111], v[80:83], v[12:15]
    ds_write_b128 v253, v[72:75] offset:16384
    v_mfma_f32_16x16x32_bf16 v[16:19], v[112:115], v[80:83], v[16:19]
    ds_write_b128 v253, v[76:79] offset:24576
    s_waitcnt lgkmcnt(0)
    s_barrier
    ds_read_b128 v[20:23], v184 offset:0
    ds_read_b128 v[24:27], v184 offset:8192
    ds_read_b128 v[28:31], v184 offset:16384
    ds_read_b128 v[32:35], v184 offset:24576
    ds_read_b128 v[36:39], v184 offset:32768
    ds_read_b128 v[40:43], v199 offset:0
    ds_read_b128 v[44:47], v199 offset:8192
    ds_read_b128 v[48:51], v199 offset:16384
    ds_read_b128 v[52:55], v199 offset:24576
    ds_read_b128 v[56:59], v199 offset:32768
    ds_read_b128 v[60:63], v200 offset:0
    ds_read_b128 v[64:67], v200 offset:8192
    ds_read_b128 v[68:71], v200 offset:16384
    ds_read_b128 v[72:75], v200 offset:24576
    ds_read_b128 v[76:79], v200 offset:32768
    ds_read_b128 v[96:99], v201 offset:0
    ds_read_b128 v[100:103], v201 offset:8192
    ds_read_b128 v[104:107], v201 offset:16384
    ds_read_b128 v[108:111], v201 offset:24576
    ds_read_b128 v[112:115], v201 offset:32768
    ds_read_b128 v[116:119], v199 offset:4096
    ds_read_b128 v[120:123], v199 offset:12288
    ds_read_b128 v[124:127], v199 offset:20480
    ds_read_b128 v[128:131], v199 offset:28672
    ds_read_b128 v[132:135], v199 offset:36864
    ds_read_b128 v[136:139], v200 offset:4096
    ds_read_b128 v[140:143], v200 offset:12288
    ds_read_b128 v[144:147], v200 offset:20480
    ds_read_b128 v[148:151], v200 offset:28672
    ds_read_b128 v[152:155], v200 offset:36864
    ds_read_b128 v[156:159], v201 offset:4096
    ds_read_b128 v[160:163], v201 offset:12288
    ds_read_b128 v[164:167], v201 offset:20480
    ds_read_b128 v[168:171], v201 offset:28672
    ds_read_b128 v[172:175], v201 offset:36864
    s_waitcnt lgkmcnt(15)
    v_pk_add_f32 v[0:1], v[0:1], v[20:21]
    v_pk_add_f32 v[2:3], v[2:3], v[22:23]
    v_pk_add_f32 v[4:5], v[4:5], v[24:25]
    v_pk_add_f32 v[6:7], v[6:7], v[26:27]
    v_pk_add_f32 v[8:9], v[8:9], v[28:29]
    v_pk_add_f32 v[10:11], v[10:11], v[30:31]
    v_pk_add_f32 v[12:13], v[12:13], v[32:33]
    v_pk_add_f32 v[14:15], v[14:15], v[34:35]
    v_pk_add_f32 v[16:17], v[16:17], v[36:37]
    v_pk_add_f32 v[18:19], v[18:19], v[38:39]
    s_waitcnt lgkmcnt(15)
    v_pk_add_f32 v[0:1], v[0:1], v[40:41]
    v_pk_add_f32 v[2:3], v[2:3], v[42:43]
    v_pk_add_f32 v[4:5], v[4:5], v[44:45]
    v_pk_add_f32 v[6:7], v[6:7], v[46:47]
    v_pk_add_f32 v[8:9], v[8:9], v[48:49]
    v_pk_add_f32 v[10:11], v[10:11], v[50:51]
    v_pk_add_f32 v[12:13], v[12:13], v[52:53]
    v_pk_add_f32 v[14:15], v[14:15], v[54:55]
    v_pk_add_f32 v[16:17], v[16:17], v[56:57]
    v_pk_add_f32 v[18:19], v[18:19], v[58:59]
    s_waitcnt lgkmcnt(15)
    v_pk_add_f32 v[0:1], v[0:1], v[60:61]
    v_pk_add_f32 v[2:3], v[2:3], v[62:63]
    v_pk_add_f32 v[4:5], v[4:5], v[64:65]
    v_pk_add_f32 v[6:7], v[6:7], v[66:67]
    v_pk_add_f32 v[8:9], v[8:9], v[68:69]
    v_pk_add_f32 v[10:11], v[10:11], v[70:71]
    v_pk_add_f32 v[12:13], v[12:13], v[72:73]
    v_pk_add_f32 v[14:15], v[14:15], v[74:75]
    v_pk_add_f32 v[16:17], v[16:17], v[76:77]
    v_pk_add_f32 v[18:19], v[18:19], v[78:79]
    s_waitcnt lgkmcnt(15)
    v_pk_add_f32 v[0:1], v[0:1], v[96:97]
    v_pk_add_f32 v[2:3], v[2:3], v[98:99]
    v_pk_add_f32 v[4:5], v[4:5], v[100:101]
    v_pk_add_f32 v[6:7], v[6:7], v[102:103]
    v_pk_add_f32 v[8:9], v[8:9], v[104:105]
    v_pk_add_f32 v[10:11], v[10:11], v[106:107]
    v_pk_add_f32 v[12:13], v[12:13], v[108:109]
    v_pk_add_f32 v[14:15], v[14:15], v[110:111]
    v_pk_add_f32 v[16:17], v[16:17], v[112:113]
    v_pk_add_f32 v[18:19], v[18:19], v[114:115]
    s_waitcnt lgkmcnt(10)
    v_pk_add_f32 v[0:1], v[0:1], v[116:117]
    v_pk_add_f32 v[2:3], v[2:3], v[118:119]
    v_pk_add_f32 v[4:5], v[4:5], v[120:121]
    v_pk_add_f32 v[6:7], v[6:7], v[122:123]
    v_pk_add_f32 v[8:9], v[8:9], v[124:125]
    v_pk_add_f32 v[10:11], v[10:11], v[126:127]
    v_pk_add_f32 v[12:13], v[12:13], v[128:129]
    v_pk_add_f32 v[14:15], v[14:15], v[130:131]
    v_pk_add_f32 v[16:17], v[16:17], v[132:133]
    v_pk_add_f32 v[18:19], v[18:19], v[134:135]
    s_waitcnt lgkmcnt(5)
    v_pk_add_f32 v[0:1], v[0:1], v[136:137]
    v_pk_add_f32 v[2:3], v[2:3], v[138:139]
    v_pk_add_f32 v[4:5], v[4:5], v[140:141]
    v_pk_add_f32 v[6:7], v[6:7], v[142:143]
    v_pk_add_f32 v[8:9], v[8:9], v[144:145]
    v_pk_add_f32 v[10:11], v[10:11], v[146:147]
    v_pk_add_f32 v[12:13], v[12:13], v[148:149]
    v_pk_add_f32 v[14:15], v[14:15], v[150:151]
    v_pk_add_f32 v[16:17], v[16:17], v[152:153]
    v_pk_add_f32 v[18:19], v[18:19], v[154:155]
    s_waitcnt lgkmcnt(0)
    v_pk_add_f32 v[0:1], v[0:1], v[156:157]
    v_pk_add_f32 v[2:3], v[2:3], v[158:159]
    v_pk_add_f32 v[4:5], v[4:5], v[160:161]
    v_pk_add_f32 v[6:7], v[6:7], v[162:163]
    v_pk_add_f32 v[8:9], v[8:9], v[164:165]
    v_pk_add_f32 v[10:11], v[10:11], v[166:167]
    v_pk_add_f32 v[12:13], v[12:13], v[168:169]
    v_pk_add_f32 v[14:15], v[14:15], v[170:171]
    v_pk_add_f32 v[16:17], v[16:17], v[172:173]
    v_pk_add_f32 v[18:19], v[18:19], v[174:175]
    v_cvt_pk_bf16_f32 v80, v0, v1
    v_cvt_pk_bf16_f32 v81, v2, v3
    v_cvt_pk_bf16_f32 v82, v4, v5
    v_cvt_pk_bf16_f32 v83, v6, v7
    v_cvt_pk_bf16_f32 v84, v8, v9
    v_cvt_pk_bf16_f32 v85, v10, v11
    v_cvt_pk_bf16_f32 v86, v12, v13
    v_cvt_pk_bf16_f32 v87, v14, v15
    v_cvt_pk_bf16_f32 v88, v16, v17
    v_cvt_pk_bf16_f32 v89, v18, v19
    buffer_store_dwordx2 v[80:81], v246, s[84:87], s81 offen offset:0 nt
    buffer_store_dwordx2 v[82:83], v246, s[84:87], s81 offen offset:32 nt
    buffer_store_dwordx2 v[84:85], v246, s[84:87], s81 offen offset:64 nt
    buffer_store_dwordx2 v[86:87], v246, s[84:87], s81 offen offset:96 nt
    buffer_store_dwordx2 v[88:89], v246, s[84:87], s81 offen offset:128 nt
K_FIN:
K_END:
    s_endpgm
.section .rodata,"a"
.p2align 6
.amdhsa_kernel parallel_sum__sliding_local_dilated__glu_gated_swiglu__prompt_kernel
  .amdhsa_next_free_vgpr 256
  .amdhsa_next_free_sgpr 102
  .amdhsa_accum_offset 256
  .amdhsa_group_segment_fixed_size 0
  .amdhsa_kernarg_size 80
  .amdhsa_user_sgpr_count 2
  .amdhsa_user_sgpr_kernarg_segment_ptr 1
  .amdhsa_system_sgpr_workgroup_id_x 1
.end_amdhsa_kernel
```
